```python
import torch

def _softmax(x, axis=-1):
    return torch.softmax(x, dim=axis)
def _gelu(x):
    return torch.nn.functional.gelu(x, approximate="tanh")
def _silu(x):
    return torch.nn.functional.silu(x)
def _sigmoid(x):
    return torch.sigmoid(x)
def _layernorm(x, axis=-1, eps=1e-5):
    m = x.mean(dim=axis, keepdim=True)
    v = x.var(dim=axis, keepdim=True, unbiased=False)
    return (x - m) / torch.sqrt(v + eps)
def _scatter_add(tgt, idx, src, axis=0):
    return tgt.clone().index_add_(axis, idx, src)
def _segment_sum(src, seg, n):
    out = torch.zeros((n,) + src.shape[1:], dtype=src.dtype)
    return out.index_add_(0, seg, src)
def _pad(x, pw):
    flat = tuple(v for pair in reversed(pw) for v in pair)
    return torch.nn.functional.pad(x, flat)

kernel_name = 'standalone__edge_featured_mpnn_mpnn__graph'

def setup_inputs():

    _w = (lambda a: (lambda t: t.to(torch.bfloat16) if t.is_floating_point() else t)(torch.as_tensor(a)))
    N, deg, D, De = 10000, 64, 64, max(4, 1)
    E = N * deg
    H = 2 * D
    return {
        "x": _w((lambda *s: torch.randn(*s, dtype=torch.bfloat16) * 0.05)(N, D)),
        "e_attr": _w((lambda *s: torch.randn(*s, dtype=torch.bfloat16) * 1.6)(E, De)),
        "src": _w((lambda lo, hi, *s: torch.randint(lo, hi, s))(0, N, E).to(torch.int64)),
        "dst": _w((lambda lo, hi, *s: torch.randint(lo, hi, s))(0, N, E).to(torch.int64)),
        "w1": _w((lambda *s: torch.randn(*s, dtype=torch.bfloat16) * 1.6)(2 * D + De, H) * (1.0 / (2 * D + De) ** 0.5)),
        "b1": _w((lambda *s: torch.randn(*s, dtype=torch.bfloat16) * 3.2)(H) * 0.01),
        "w2": _w((lambda *s: torch.randn(*s, dtype=torch.bfloat16) * 0.05)(H, D) * (1.0 / H ** 0.5)),
        "b2": _w((lambda *s: torch.randn(*s, dtype=torch.bfloat16) * 0.05)(D) * 0.01),
    }

def reference(x, e_attr, src, dst, w1, b1, w2, b2):
    N, D = x.shape
    h_src = x[src]
    h_dst = x[dst]
    m_in = torch.concatenate([h_src, h_dst, e_attr], axis=-1)
    h = _silu(m_in @ w1 + b1)
    msg = h @ w2 + b2
    return _segment_sum(msg, dst, N)
```

```asm
; @launch kernel=sort_kernel grid=(256,1,1) block=(640,1,1) lds=28672
; @launch kernel=main_kernel grid=(256,1,1) block=(512,1,1) lds=163648
.amdgcn_target "amdgcn-amd-amdhsa--gfx950"
.text
.globl sort_kernel
.p2align 8
.type sort_kernel,@function
sort_kernel:
    s_cmp_ge_u32 s2, 256
    s_cbranch_scc1 K1_END
    s_load_dwordx4 s[4:7], s[0:1], 16
    s_load_dwordx2 s[8:9], s[0:1], 80
    s_load_dwordx2 s[10:11], s[0:1], 32
    s_load_dwordx2 s[20:21], s[0:1], 48
    s_load_dwordx4 s[60:63], s[0:1], 0
    s_load_dwordx2 s[46:47], s[0:1], 56
    v_lshlrev_b32 v1, 4, v0
    v_and_b32 v2, 63, v0
    s_mul_i32 s22, s2, 10240
    s_mov_b32 s28, 214749
    s_movk_i32 s29, -625
    s_cmp_ge_u32 s2, 250
    s_cbranch_scc1 K1_PREP
    s_waitcnt lgkmcnt(0)
    s_mov_b32 s16, s6
    s_and_b32 s17, s7, 0xffff
    s_mov_b32 s18, 0x271000
    s_mov_b32 s19, 0x20000
    s_mov_b32 s12, s4
    s_and_b32 s13, s5, 0xffff
    s_mov_b32 s14, 0x271000
    s_mov_b32 s15, 0x20000
    buffer_load_dwordx4 v[4:7], v1, s[16:19], s22 offen
    buffer_load_dwordx4 v[8:11], v1, s[12:15], s22 offen
    s_mov_b32 s24, s8
    s_and_b32 s25, s9, 0xffff
    s_mov_b32 s26, 0x690000
    s_mov_b32 s27, 0x20000
    s_mov_b32 s36, s60
    s_and_b32 s37, s61, 0xffff
    s_mov_b32 s38, 0x138800
    s_mov_b32 s39, 0x20000
    s_mul_i32 s23, s2, 5120
    v_lshlrev_b32 v60, 3, v0
    buffer_load_dwordx2 v[60:61], v60, s[36:39], s23 offen
    v_mov_b32 v12, 0
    v_mov_b32 v13, 1
    v_lshlrev_b32 v3, 2, v0
    v_cmp_gt_u32 vcc, 256, v0
    s_and_saveexec_b64 s[30:31], vcc
    s_cbranch_execz K1_Z
    ds_write_b32 v3, v12
K1_Z:
    s_mov_b64 exec, s[30:31]
    v_mov_b32 v28, -1
    v_mov_b32 v29, -1
    v_mov_b32 v30, -1
    v_mov_b32 v31, -1
    ds_write_b128 v1, v[28:31] offset:2048
    v_cmp_gt_u32 vcc, 384, v0
    s_and_saveexec_b64 s[30:31], vcc
    s_cbranch_execz K1_Z2
    ds_write_b128 v1, v[28:31] offset:12288
K1_Z2:
    s_mov_b64 exec, s[30:31]
    v_lshlrev_b32 v14, 22, v0
    s_waitcnt lgkmcnt(0)
    s_barrier
    s_waitcnt vmcnt(2)
    v_mul_u32_u24 v16, s28, v4
    v_mul_u32_u24 v17, s28, v5
    v_mul_u32_u24 v18, s28, v6
    v_mul_u32_u24 v19, s28, v7
    v_lshlrev_b32 v20, 4, v4
    v_lshlrev_b32 v21, 4, v5
    v_lshlrev_b32 v22, 4, v6
    v_lshlrev_b32 v23, 4, v7
    v_bfe_u32 v16, v16, 23, 8
    v_bfe_u32 v17, v17, 23, 8
    v_bfe_u32 v18, v18, 23, 8
    v_bfe_u32 v19, v19, 23, 8
    v_mad_i32_i24 v20, v16, s29, v20
    v_mad_i32_i24 v21, v17, s29, v21
    v_mad_i32_i24 v22, v18, s29, v22
    v_mad_i32_i24 v23, v19, s29, v23
    v_lshlrev_b32 v16, 2, v16
    ds_add_rtn_u32 v24, v16, v13
    v_lshlrev_b32 v17, 2, v17
    ds_add_rtn_u32 v25, v17, v13
    v_lshlrev_b32 v18, 2, v18
    ds_add_rtn_u32 v26, v18, v13
    v_lshlrev_b32 v19, 2, v19
    ds_add_rtn_u32 v27, v19, v13
    v_bfe_u32 v20, v20, 4, 6
    v_bfe_u32 v21, v21, 4, 6
    v_bfe_u32 v22, v22, 4, 6
    v_bfe_u32 v23, v23, 4, 6
    s_waitcnt vmcnt(1)
    v_lshl_or_b32 v20, v8, 6, v20
    v_or_b32 v20, v20, v14
    v_add_u32 v14, 0x100000, v14
    v_lshl_or_b32 v21, v9, 6, v21
    v_or_b32 v21, v21, v14
    v_add_u32 v14, 0x100000, v14
    v_lshl_or_b32 v22, v10, 6, v22
    v_or_b32 v22, v22, v14
    v_add_u32 v14, 0x100000, v14
    v_lshl_or_b32 v23, v11, 6, v23
    v_or_b32 v23, v23, v14
    s_waitcnt lgkmcnt(0)
    s_barrier
    v_lshlrev_b32 v28, 4, v2
    ds_read_b128 v[32:35], v28
    s_waitcnt lgkmcnt(0)
    v_add_u32 v48, -12, v32
    v_add_u32 v49, -12, v33
    v_add_u32 v50, -12, v34
    v_add_u32 v51, -12, v35
    v_and_b32 v48, -4, v48
    v_and_b32 v49, -4, v49
    v_and_b32 v50, -4, v50
    v_and_b32 v51, -4, v51
    v_cmp_lt_u32 s[32:33], 16, v32
    v_cmp_lt_u32 s[34:35], 16, v33
    v_cmp_lt_u32 s[36:37], 16, v34
    v_cmp_lt_u32 s[38:39], 16, v35
    s_nop 0
    v_cndmask_b32 v48, 0, v48, s[32:33]
    v_cndmask_b32 v49, 0, v49, s[34:35]
    v_cndmask_b32 v50, 0, v50, s[36:37]
    v_cndmask_b32 v51, 0, v51, s[38:39]
    v_add_u32 v36, v48, v49
    v_add_u32 v37, v50, v51
    v_add_u32 v36, v36, v37
    v_mov_b32 v37, v36
    s_nop 1
    v_add_u32_dpp v37, v37, v37 row_shr:1 row_mask:0xf bank_mask:0xf bound_ctrl:0
    s_nop 1
    v_add_u32_dpp v37, v37, v37 row_shr:2 row_mask:0xf bank_mask:0xf bound_ctrl:0
    s_nop 1
    v_add_u32_dpp v37, v37, v37 row_shr:4 row_mask:0xf bank_mask:0xf bound_ctrl:0
    s_nop 1
    v_add_u32_dpp v37, v37, v37 row_shr:8 row_mask:0xf bank_mask:0xf bound_ctrl:0
    s_nop 1
    v_add_u32_dpp v37, v37, v37 row_bcast:15 row_mask:0xa bank_mask:0xf
    s_nop 1
    v_add_u32_dpp v37, v37, v37 row_bcast:31 row_mask:0xc bank_mask:0xf
    v_sub_u32 v40, v37, v36
    v_add_u32 v41, v40, v48
    v_add_u32 v42, v41, v49
    v_add_u32 v43, v42, v50
    v_readlane_b32 s40, v37, 63
    v_lshlrev_b32 v52, 2, v40
    v_lshlrev_b32 v53, 2, v41
    v_lshlrev_b32 v54, 2, v42
    v_lshlrev_b32 v55, 2, v43
    v_add_u32 v52, 16324, v52
    v_add_u32 v53, 16324, v53
    v_add_u32 v54, 16324, v54
    v_add_u32 v55, 16324, v55
    v_cndmask_b32 v56, 16, 15, s[32:33]
    v_cndmask_b32 v57, 16, 15, s[34:35]
    v_cndmask_b32 v58, 16, 15, s[36:37]
    v_cndmask_b32 v59, 16, 15, s[38:39]
    v_lshl_or_b32 v52, v52, 8, v56
    v_lshl_or_b32 v53, v53, 8, v57
    v_lshl_or_b32 v54, v54, 8, v58
    v_lshl_or_b32 v55, v55, 8, v59
    ds_write_b128 v28, v[52:55] offset:1024
    ds_read_b32 v44, v16 offset:1024
    ds_read_b32 v45, v17 offset:1024
    ds_read_b32 v46, v18 offset:1024
    ds_read_b32 v47, v19 offset:1024
    v_lshlrev_b32 v16, 4, v16
    v_lshlrev_b32 v17, 4, v17
    v_lshlrev_b32 v18, 4, v18
    v_lshlrev_b32 v19, 4, v19
    v_lshl_add_u32 v16, v24, 2, v16
    v_lshl_add_u32 v17, v25, 2, v17
    v_lshl_add_u32 v18, v26, 2, v18
    v_lshl_add_u32 v19, v27, 2, v19
    v_cmp_gt_u32 vcc, 64, v0
    s_and_saveexec_b64 s[30:31], vcc
    s_cbranch_execz K1_P
    v_lshlrev_b32 v56, 8, v2
    s_mov_b32 s23, 0xf0000000
    v_add_u32 v57, -15, v32
    v_lshl_or_b32 v57, v40, 12, v57
    v_or_b32 v57, s23, v57
    s_mov_b64 exec, s[32:33]
    ds_write_b32 v56, v57 offset:2108
    s_mov_b64 exec, -1
    v_add_u32 v57, -15, v33
    v_lshl_or_b32 v57, v41, 12, v57
    v_or_b32 v57, s23, v57
    s_mov_b64 exec, s[34:35]
    ds_write_b32 v56, v57 offset:2172
    s_mov_b64 exec, -1
    v_add_u32 v57, -15, v34
    v_lshl_or_b32 v57, v42, 12, v57
    v_or_b32 v57, s23, v57
    s_mov_b64 exec, s[36:37]
    ds_write_b32 v56, v57 offset:2236
    s_mov_b64 exec, -1
    v_add_u32 v57, -15, v35
    v_lshl_or_b32 v57, v43, 12, v57
    v_or_b32 v57, s23, v57
    s_mov_b64 exec, s[38:39]
    ds_write_b32 v56, v57 offset:2300
    s_mov_b64 exec, -1
K1_P:
    s_mov_b64 exec, s[30:31]
    s_waitcnt lgkmcnt(0)
    v_and_b32 v32, 0xff, v44
    v_lshrrev_b32 v33, 8, v44
    v_cmp_lt_u32 vcc, v24, v32
    v_lshl_add_u32 v33, v24, 2, v33
    s_nop 0
    v_cndmask_b32 v33, v33, v16, vcc
    ds_write_b32 v33, v20 offset:2048
    v_and_b32 v32, 0xff, v45
    v_lshrrev_b32 v33, 8, v45
    v_cmp_lt_u32 vcc, v25, v32
    v_lshl_add_u32 v33, v25, 2, v33
    s_nop 0
    v_cndmask_b32 v33, v33, v17, vcc
    ds_write_b32 v33, v21 offset:2048
    v_and_b32 v32, 0xff, v46
    v_lshrrev_b32 v33, 8, v46
    v_cmp_lt_u32 vcc, v26, v32
    v_lshl_add_u32 v33, v26, 2, v33
    s_nop 0
    v_cndmask_b32 v33, v33, v18, vcc
    ds_write_b32 v33, v22 offset:2048
    v_and_b32 v32, 0xff, v47
    v_lshrrev_b32 v33, 8, v47
    v_cmp_lt_u32 vcc, v27, v32
    v_lshl_add_u32 v33, v27, 2, v33
    s_nop 0
    v_cndmask_b32 v33, v33, v19, vcc
    ds_write_b32 v33, v23 offset:2048
    s_waitcnt lgkmcnt(0)
    s_barrier
    ds_read_b128 v[4:7], v1 offset:2048
    ds_read_b128 v[8:11], v1 offset:12288
    ds_read_b128 v[40:43], v1 offset:18432
    v_lshrrev_b32 v12, 2, v0
    v_and_b32 v13, 3, v0
    v_lshlrev_b32 v13, 4, v13
    v_lshl_add_u32 v12, v12, 14, v13
    s_lshl_b32 s22, s2, 6
    v_add_u32 v14, 2621440, v12
    s_mul_i32 s23, s2, 10240
    s_add_u32 s23, s23, 4194304
    s_lshl_b32 s40, s40, 2
    v_cmp_gt_u32 vcc, 384, v0
    v_cmp_gt_u32 s[32:33], s40, v1
    s_waitcnt lgkmcnt(0)
    buffer_store_dwordx4 v[4:7], v12, s[24:27], s22 offen sc1
    s_mov_b64 exec, vcc
    s_cbranch_execz K1_C2
    buffer_store_dwordx4 v[8:11], v14, s[24:27], s22 offen sc1
K1_C2:
    s_mov_b64 exec, s[32:33]
    s_cbranch_execz K1_C3
    buffer_store_dwordx4 v[40:43], v1, s[24:27], s23 offen sc1
K1_C3:
    s_mov_b64 exec, -1
    s_endpgm
K1_PREP:
    v_lshrrev_b32 v3, 6, v0
    v_and_b32 v4, 31, v2
    v_lshrrev_b32 v5, 5, v2
    v_readfirstlane_b32 s23, v3
    s_sub_u32 s22, s2, 250
    s_mul_i32 s22, s22, 10
    s_add_u32 s22, s22, s23
    s_cmp_ge_u32 s22, 54
    s_cbranch_scc1 K1_END
    s_waitcnt lgkmcnt(0)
    s_mov_b32 s12, s10
    s_and_b32 s13, s11, 0xffff
    s_mov_b32 s14, 0x8400
    s_mov_b32 s15, 0x20000
    s_mov_b32 s16, s20
    s_and_b32 s17, s21, 0xffff
    s_mov_b32 s18, 0x4000
    s_mov_b32 s19, 0x20000
    s_mov_b32 s24, s8
    s_and_b32 s25, s9, 0xffff
    s_mov_b32 s26, 0x690000
    s_mov_b32 s27, 0x20000
    s_mov_b32 s30, 0xbfb8aa3b
    v_lshlrev_b32 v6, 4, v2
    s_lshl_b32 s31, s22, 10
    s_add_u32 s31, s31, 6815744
    v_lshlrev_b32 v7, 1, v4
    s_cmp_ge_u32 s22, 52
    s_cbranch_scc1 K1_B2
    s_cmp_ge_u32 s22, 36
    s_cbranch_scc1 K1_W2
    s_cmp_ge_u32 s22, 20
    s_cbranch_scc1 K1_W1D
    s_cmp_ge_u32 s22, 16
    s_cbranch_scc1 K1_WE
    s_mov_b32 s32, s22
    v_lshl_add_u32 v8, v5, 13, v7
    s_and_b32 s33, s32, 3
    s_lshl_b32 s33, s33, 11
    s_lshr_b32 s34, s32, 2
    s_lshl_b32 s34, s34, 6
    s_add_u32 s33, s33, s34
    buffer_load_ushort v10, v8, s[12:15], s33 offen offset:0
    buffer_load_ushort v11, v8, s[12:15], s33 offen offset:256
    buffer_load_ushort v12, v8, s[12:15], s33 offen offset:512
    buffer_load_ushort v13, v8, s[12:15], s33 offen offset:768
    buffer_load_ushort v14, v8, s[12:15], s33 offen offset:1024
    buffer_load_ushort v15, v8, s[12:15], s33 offen offset:1280
    buffer_load_ushort v16, v8, s[12:15], s33 offen offset:1536
    buffer_load_ushort v17, v8, s[12:15], s33 offen offset:1792
    s_waitcnt vmcnt(0)
    v_lshlrev_b32 v10, 16, v10
    v_mul_f32 v10, s30, v10
    v_lshlrev_b32 v11, 16, v11
    v_mul_f32 v11, s30, v11
    v_lshlrev_b32 v12, 16, v12
    v_mul_f32 v12, s30, v12
    v_lshlrev_b32 v13, 16, v13
    v_mul_f32 v13, s30, v13
    v_lshlrev_b32 v14, 16, v14
    v_mul_f32 v14, s30, v14
    v_lshlrev_b32 v15, 16, v15
    v_mul_f32 v15, s30, v15
    v_lshlrev_b32 v16, 16, v16
    v_mul_f32 v16, s30, v16
    v_lshlrev_b32 v17, 16, v17
    v_mul_f32 v17, s30, v17
    v_cvt_pk_bf16_f32 v20, v10, v11
    v_cvt_pk_bf16_f32 v21, v12, v13
    v_cvt_pk_bf16_f32 v22, v14, v15
    v_cvt_pk_bf16_f32 v23, v16, v17
    s_branch K1_ST
K1_W1D:
    s_sub_u32 s32, s22, 20
    v_lshl_add_u32 v8, v5, 13, v7
    s_and_b32 s33, s32, 3
    s_lshl_b32 s33, s33, 11
    s_lshr_b32 s34, s32, 2
    s_lshl_b32 s34, s34, 6
    s_add_u32 s33, s33, s34
    s_add_u32 s33, s33, 16384
    buffer_load_ushort v10, v8, s[12:15], s33 offen offset:0
    buffer_load_ushort v11, v8, s[12:15], s33 offen offset:256
    buffer_load_ushort v12, v8, s[12:15], s33 offen offset:512
    buffer_load_ushort v13, v8, s[12:15], s33 offen offset:768
    buffer_load_ushort v14, v8, s[12:15], s33 offen offset:1024
    buffer_load_ushort v15, v8, s[12:15], s33 offen offset:1280
    buffer_load_ushort v16, v8, s[12:15], s33 offen offset:1536
    buffer_load_ushort v17, v8, s[12:15], s33 offen offset:1792
    s_waitcnt vmcnt(0)
    v_lshl_or_b32 v20, v11, 16, v10
    v_lshl_or_b32 v21, v13, 16, v12
    v_lshl_or_b32 v22, v15, 16, v14
    v_lshl_or_b32 v23, v17, 16, v16
    s_branch K1_ST
K1_WE:
    s_sub_u32 s32, s22, 16
    s_lshl_b32 s33, s32, 6
    s_add_u32 s33, s33, 32768
    buffer_load_ushort v10, v7, s[12:15], s33 offen offset:0
    buffer_load_ushort v11, v7, s[12:15], s33 offen offset:256
    buffer_load_ushort v12, v7, s[12:15], s33 offen offset:512
    buffer_load_ushort v13, v7, s[12:15], s33 offen offset:768
    s_waitcnt vmcnt(0)
    v_lshlrev_b32 v10, 16, v10
    v_mul_f32 v10, s30, v10
    v_lshlrev_b32 v11, 16, v11
    v_mul_f32 v11, s30, v11
    v_lshlrev_b32 v12, 16, v12
    v_mul_f32 v12, s30, v12
    v_lshlrev_b32 v13, 16, v13
    v_mul_f32 v13, s30, v13
    v_cvt_pk_bf16_f32 v20, v10, v11
    v_cvt_pk_bf16_f32 v21, v12, v13
    v_lshlrev_b32 v14, 16, v20
    v_and_b32 v15, 0xffff0000, v20
    v_sub_f32 v14, v10, v14
    v_sub_f32 v15, v11, v15
    v_cvt_pk_bf16_f32 v16, v14, v15
    v_lshlrev_b32 v14, 16, v21
    v_and_b32 v15, 0xffff0000, v21
    v_sub_f32 v14, v12, v14
    v_sub_f32 v15, v13, v15
    v_cvt_pk_bf16_f32 v17, v14, v15
    v_cmp_eq_u32 vcc, 1, v5
    s_nop 1
    v_cndmask_b32 v20, v20, v16, vcc
    v_cndmask_b32 v21, v21, v17, vcc
    v_mov_b32 v22, 0
    v_mov_b32 v23, 0
    s_branch K1_ST
K1_B2:
    s_mov_b32 s36, s46
    s_and_b32 s37, s47, 0xffff
    s_mov_b32 s38, 0x80
    s_mov_b32 s39, 0x20000
    s_sub_u32 s32, s22, 52
    s_lshl_b32 s33, s32, 6
    buffer_load_ushort v10, v7, s[36:39], s33 offen
    v_cmp_eq_u32 vcc, 0, v5
    v_mov_b32 v22, 0
    v_mov_b32 v23, 0
    s_waitcnt vmcnt(0)
    v_cndmask_b32 v21, 0, v10, vcc
    v_lshl_or_b32 v20, v21, 16, v21
    s_branch K1_ST
K1_W2:
    s_sub_u32 s32, s22, 36
    s_and_b32 s33, s32, 7
    s_lshl_b32 s33, s33, 11
    s_lshr_b32 s34, s32, 3
    s_lshl_b32 s34, s34, 6
    s_add_u32 s33, s33, s34
    v_lshl_add_u32 v8, v5, 10, v7
    buffer_load_ushort v10, v8, s[16:19], s33 offen offset:0
    buffer_load_ushort v11, v8, s[16:19], s33 offen offset:128
    buffer_load_ushort v12, v8, s[16:19], s33 offen offset:256
    buffer_load_ushort v13, v8, s[16:19], s33 offen offset:384
    buffer_load_ushort v14, v8, s[16:19], s33 offen offset:512
    buffer_load_ushort v15, v8, s[16:19], s33 offen offset:640
    buffer_load_ushort v16, v8, s[16:19], s33 offen offset:768
    buffer_load_ushort v17, v8, s[16:19], s33 offen offset:896
    s_waitcnt vmcnt(0)
    v_lshl_or_b32 v20, v11, 16, v10
    v_lshl_or_b32 v21, v13, 16, v12
    v_lshl_or_b32 v22, v15, 16, v14
    v_lshl_or_b32 v23, v17, 16, v16
K1_ST:
    buffer_store_dwordx4 v[20:23], v6, s[24:27], s31 offen sc1
K1_END:
    s_endpgm
.globl main_kernel
.p2align 8
.type main_kernel,@function
main_kernel:
    s_cmp_ge_u32 s2, 256
    s_cbranch_scc1 K2_END
    s_load_dwordx2 s[52:53], s[0:1], 80
    s_load_dwordx4 s[40:43], s[0:1], 0
    s_load_dwordx2 s[44:45], s[0:1], 40
    s_load_dwordx4 s[60:63], s[0:1], 56
    v_and_b32 v1, 63, v0
    v_lshrrev_b32 v2, 6, v0
    v_lshlrev_b32 v4, 4, v0
    v_mov_b32 v40, -1
    v_mov_b32 v41, -1
    v_mov_b32 v42, -1
    v_mov_b32 v43, -1
    v_readfirstlane_b32 s20, v2
    s_lshl_b32 s46, s2, 14
    v_cmp_gt_u32 vcc, 488, v0
    s_waitcnt lgkmcnt(0)
    s_mov_b32 s12, s52
    s_and_b32 s13, s53, 0xffff
    s_mov_b32 s14, 0x690000
    s_mov_b32 s15, 0x20000
    buffer_load_dwordx4 v[32:35], v4, s[12:15], s46 offen
    s_add_u32 s46, s46, 8192
    s_and_saveexec_b64 s[48:49], vcc
    buffer_load_dwordx4 v[40:43], v4, s[12:15], s46 offen
    s_mov_b64 exec, s[48:49]
    v_mov_b32 v112, 0
    v_cmp_gt_u32 vcc, 208, v0
    s_and_saveexec_b64 s[46:47], vcc
    s_cbranch_execz K2_I0
    v_lshlrev_b32 v27, 2, v0
    v_add_u32 v27, 162816, v27
    ds_write_b32 v27, v112
K2_I0:
    s_mov_b64 exec, s[46:47]
    s_waitcnt lgkmcnt(0)
    s_barrier
    s_mul_i32 s46, s2, 625
    s_add_u32 s47, s46, 15
    s_lshr_b32 s21, s47, 4
    s_add_u32 s47, s46, 640
    s_lshr_b32 s47, s47, 4
    s_sub_u32 s22, s47, s21
    v_and_b32 v2, 31, v1
    v_lshrrev_b32 v3, 5, v1
    v_lshlrev_b32 v24, 1, v2
    v_lshlrev_b32 v25, 4, v1
    s_cmp_ge_u32 s20, 5
    s_cselect_b32 s50, 3, 0
    s_sub_u32 s50, s20, s50
    v_and_b32 v8, 7, v1
    v_lshrrev_b32 v9, 4, v1
    v_xor_b32 v8, v8, v9
    v_lshlrev_b32 v209, 4, v8
    v_xor_b32 v211, 64, v209
    s_and_b32 s47, s50, 1
    s_lshl_b32 s47, s47, 6
    v_xor_b32 v8, s47, v209
    v_lshrrev_b32 v9, 3, v1
    v_lshl_add_u32 v8, v9, 7, v8
    s_mov_b32 s16, s40
    s_and_b32 s17, s41, 0xffff
    s_mov_b32 s18, 0x138800
    s_mov_b32 s19, 0x20000
    s_lshl_b32 s47, s50, 10
    s_add_u32 m0, s47, 68608
    s_lshl_b32 s48, s21, 7
    s_add_u32 s47, s47, s48
    buffer_load_dwordx4 v8, s[16:19], s47 offen lds
    s_cmp_ge_u32 s20, 4
    s_cbranch_scc1 K2_NQ0
    s_lshl_b32 s48, s20, 12
    s_add_u32 s48, s48, 6836224
    buffer_load_dwordx4 v[64:67], v25, s[12:15], s48 offen offset:0
    buffer_load_dwordx4 v[68:71], v25, s[12:15], s48 offen offset:1024
    buffer_load_dwordx4 v[72:75], v25, s[12:15], s48 offen offset:2048
    buffer_load_dwordx4 v[76:79], v25, s[12:15], s48 offen offset:3072
    s_mov_b32 s56, s44
    s_and_b32 s57, s45, 0xffff
    s_mov_b32 s58, 0x100
    s_mov_b32 s59, 0x20000
    s_lshl_b32 s47, s20, 6
    buffer_load_ushort v24, v24, s[56:59], s47 offen
K2_NQ0:
    v_lshlrev_b32 v26, 4, v0
    v_add_u32 v26, 101376, v26
    v_mov_b32 v112, 0
    v_mov_b32 v113, 0
    v_mov_b32 v114, 0
    v_mov_b32 v115, 0
    ds_write_b128 v26, v[112:115] offset:0
    ds_write_b128 v26, v[112:115] offset:8192
    ds_write_b128 v26, v[112:115] offset:16384
    ds_write_b128 v26, v[112:115] offset:24576
    ds_write_b128 v26, v[112:115] offset:32768
    s_sub_u32 s48, s40, 3072
    s_subb_u32 s49, s41, 0
    s_mov_b32 s4, s48
    s_and_b32 s5, s49, 0xffff
    s_or_b32 s5, s5, 0x800000
    s_mov_b32 s6, 0x2710
    s_mov_b32 s7, 0x20000
    s_mov_b32 s8, s42
    s_and_b32 s9, s43, 0xffff
    s_mov_b32 s10, 0x4e2000
    s_mov_b32 s11, 0x20000
    v_lshrrev_b32 v26, 2, v0
    v_and_b32 v27, 3, v0
    v_lshlrev_b32 v27, 2, v27
    s_movk_i32 s46, 2560
    v_mul_u32_u24 v30, s46, v26
    v_add_lshl_u32 v30, v30, v27, 2
    v_add_u32 v30, 4194304, v30
    v_add_u32 v31, 1310720, v30
    s_lshl_b32 s36, s20, 12
    s_add_u32 s36, s36, 68608
    v_bfe_u32 v4, v2, 1, 3
    v_lshlrev_b32 v5, 2, v3
    v_xor_b32 v4, v4, v5
    v_lshlrev_b32 v4, 4, v4
    v_lshl_add_u32 v20, v2, 7, v4
    v_add_u32 v216, s36, v20
    v_xor_b32 v217, 16, v216
    v_xor_b32 v218, 32, v216
    v_xor_b32 v219, 48, v216
    v_add_u32 v213, 1024, v209
    v_mov_b32 v215, v211
    v_add_u32 v209, 3072, v209
    v_add_u32 v211, 2048, v211
    v_lshrrev_b32 v4, 3, v1
    v_and_b32 v5, 3, v4
    v_lshrrev_b32 v4, 2, v4
    v_lshl_add_u32 v4, v5, 1, v4
    v_lshlrev_b32 v220, 4, v4
    v_and_b32 v4, 24, v2
    v_and_b32 v5, 3, v2
    v_lshl_add_u32 v4, v5, 1, v4
    v_bfe_u32 v5, v2, 2, 1
    v_add_lshl_u32 v221, v4, v5, 4
    v_lshlrev_b32 v4, 2, v2
    v_add_u32 v222, 48128, v4
    v_lshlrev_b32 v4, 3, v2
    v_add_u32 v223, 101376, v4
    v_mov_b32 v228, 1.0
    v_mov_b32 v229, 1.0
    s_mov_b32 s37, 0x67800000
    s_lshl_b32 s46, s20, 2
    s_add_u32 s47, s46, 163616
    v_mov_b32 v231, s47
    s_xor_b32 s46, s46, 16
    s_add_u32 s47, s46, 163616
    v_mov_b32 v230, s47
    s_movk_i32 s46, 0x5000
    v_lshrrev_b32 v26, 2, v0
    v_mul_u32_u24 v26, s46, v26
    v_add_u32 v239, 0x280000, v26
    v_mov_b32 v238, 0x3f803f80
    v_mov_b32 v9, 1
    s_cmp_ge_u32 s20, 4
    s_cbranch_scc1 K2_NQ1
    s_waitcnt vmcnt(6)
    s_branch K2_NQ2
K2_NQ1:
    s_waitcnt vmcnt(1)
K2_NQ2:
    v_mov_b32_dpp v5, v35 quad_perm:[3,3,3,3] row_mask:0xf bank_mask:0xf
    v_mov_b32_dpp v6, v43 quad_perm:[3,3,3,3] row_mask:0xf bank_mask:0xf
    s_mov_b32 s46, 0xf0000000
    v_add_u32 v7, 1, v5
    v_add_u32 v8, 1, v6
    v_cmp_lt_u32 vcc, s46, v7
    v_cmp_lt_u32 s[46:47], s46, v8
    v_and_b32 v28, 0xfff, v5
    v_and_b32 v29, 0xfff, v6
    v_bfe_u32 v5, v5, 12, 12
    v_bfe_u32 v6, v6, 12, 12
    v_cndmask_b32 v28, 0, v28, vcc
    v_cndmask_b32 v29, 0, v29, s[46:47]
    v_lshl_add_u32 v30, v5, 2, v30
    v_lshl_add_u32 v31, v6, 2, v31
    v_max_u32 v5, v28, v29
    v_sub_u32 v28, v28, v27
    v_sub_u32 v29, v29, v27
    v_cmp_lt_u32 s[64:65], 16, v5
    v_cmpx_lt_i32 vcc, 0, v28
    s_cbranch_execz K2_NA1
    buffer_load_dwordx4 v[36:39], v30, s[12:15], 0 offen
K2_NA1:
    s_mov_b64 exec, -1
    v_cmpx_lt_i32 vcc, 0, v29
    s_cbranch_execz K2_NB1
    buffer_load_dwordx4 v[44:47], v31, s[12:15], 0 offen
K2_NB1:
    s_mov_b64 exec, -1
    s_cmp_eq_u64 s[64:65], 0
    s_cbranch_scc1 K2_NF
    v_mov_b32 v5, 163584
    v_mov_b32 v6, 1
    ds_write_b32 v5, v6
K2_NF:
    s_mov_b32 s46, 162816
    s_mov_b32 s51, 0xa0000000
    v_and_b32 v80, 63, v32
    v_lshl_add_u32 v80, v80, 2, s46
    v_and_b32 v81, 63, v33
    v_lshl_add_u32 v81, v81, 2, s46
    v_and_b32 v82, 63, v34
    v_lshl_add_u32 v82, v82, 2, s46
    v_and_b32 v83, 63, v35
    v_lshl_add_u32 v83, v83, 2, s46
    v_cmpx_gt_u32 vcc, s51, v32
    ds_add_rtn_u32 v96, v80, v9
    v_cmpx_gt_u32 vcc, s51, v33
    ds_add_rtn_u32 v97, v81, v9
    v_cmpx_gt_u32 vcc, s51, v34
    ds_add_rtn_u32 v98, v82, v9
    v_cmpx_gt_u32 vcc, s51, v35
    ds_add_rtn_u32 v99, v83, v9
K2_R0:
    s_mov_b64 exec, -1
    v_and_b32 v88, 63, v40
    v_lshl_add_u32 v88, v88, 2, s46
    v_and_b32 v89, 63, v41
    v_lshl_add_u32 v89, v89, 2, s46
    v_and_b32 v90, 63, v42
    v_lshl_add_u32 v90, v90, 2, s46
    v_and_b32 v91, 63, v43
    v_lshl_add_u32 v91, v91, 2, s46
    v_cmpx_gt_u32 vcc, s51, v40
    ds_add_rtn_u32 v104, v88, v9
    v_cmpx_gt_u32 vcc, s51, v41
    ds_add_rtn_u32 v105, v89, v9
    v_cmpx_gt_u32 vcc, s51, v42
    ds_add_rtn_u32 v106, v90, v9
    v_cmpx_gt_u32 vcc, s51, v43
    ds_add_rtn_u32 v107, v91, v9
K2_R2:
    s_mov_b64 exec, -1
    v_bfe_i32 v4, v32, 0, 1
    v_bfe_u32 v48, v32, 6, 14
    v_lshrrev_b32 v49, 20, v32
    v_and_b32 v51, v238, v4
    v_lshl_add_u32 v49, v49, 3, v26
    v_xor_b32 v50, v238, v51
    v_bfe_i32 v4, v33, 0, 1
    v_bfe_u32 v52, v33, 6, 14
    v_lshrrev_b32 v53, 20, v33
    v_and_b32 v55, v238, v4
    v_lshl_add_u32 v53, v53, 3, v26
    v_xor_b32 v54, v238, v55
    v_bfe_i32 v4, v34, 0, 1
    v_bfe_u32 v56, v34, 6, 14
    v_lshrrev_b32 v57, 20, v34
    v_and_b32 v59, v238, v4
    v_lshl_add_u32 v57, v57, 3, v26
    v_xor_b32 v58, v238, v59
    v_bfe_i32 v4, v35, 0, 1
    v_bfe_u32 v60, v35, 6, 14
    v_lshrrev_b32 v61, 20, v35
    v_and_b32 v63, v238, v4
    v_lshl_add_u32 v61, v61, 3, v26
    v_xor_b32 v62, v238, v63
    v_bfe_i32 v4, v40, 0, 1
    v_bfe_u32 v112, v40, 6, 14
    v_lshrrev_b32 v113, 20, v40
    v_and_b32 v115, v238, v4
    v_lshl_add_u32 v113, v113, 3, v239
    v_xor_b32 v114, v238, v115
    v_bfe_i32 v4, v41, 0, 1
    v_bfe_u32 v116, v41, 6, 14
    v_lshrrev_b32 v117, 20, v41
    v_and_b32 v119, v238, v4
    v_lshl_add_u32 v117, v117, 3, v239
    v_xor_b32 v118, v238, v119
    v_bfe_i32 v4, v42, 0, 1
    v_bfe_u32 v120, v42, 6, 14
    v_lshrrev_b32 v121, 20, v42
    v_and_b32 v123, v238, v4
    v_lshl_add_u32 v121, v121, 3, v239
    v_xor_b32 v122, v238, v123
    v_bfe_i32 v4, v43, 0, 1
    v_bfe_u32 v124, v43, 6, 14
    v_lshrrev_b32 v125, 20, v43
    v_and_b32 v127, v238, v4
    v_lshl_add_u32 v125, v125, 3, v239
    v_xor_b32 v126, v238, v127
    s_waitcnt vmcnt(0)
    v_cmpx_lt_i32 vcc, 0, v28
    s_cbranch_execz K2_R1
    v_and_b32 v84, 63, v36
    v_lshl_add_u32 v84, v84, 2, s46
    v_and_b32 v85, 63, v37
    v_lshl_add_u32 v85, v85, 2, s46
    v_and_b32 v86, 63, v38
    v_lshl_add_u32 v86, v86, 2, s46
    v_and_b32 v87, 63, v39
    v_lshl_add_u32 v87, v87, 2, s46
    ds_add_rtn_u32 v100, v84, v9
    v_cmpx_lt_i32 vcc, 1, v28
    ds_add_rtn_u32 v101, v85, v9
    v_cmpx_lt_i32 vcc, 2, v28
    ds_add_rtn_u32 v102, v86, v9
    v_cmpx_lt_i32 vcc, 3, v28
    ds_add_rtn_u32 v103, v87, v9
K2_R1:
    s_mov_b64 exec, -1
    v_cmpx_lt_i32 vcc, 0, v29
    s_cbranch_execz K2_R3
    v_and_b32 v92, 63, v44
    v_lshl_add_u32 v92, v92, 2, s46
    v_and_b32 v93, 63, v45
    v_lshl_add_u32 v93, v93, 2, s46
    v_and_b32 v94, 63, v46
    v_lshl_add_u32 v94, v94, 2, s46
    v_and_b32 v95, 63, v47
    v_lshl_add_u32 v95, v95, 2, s46
    ds_add_rtn_u32 v108, v92, v9
    v_cmpx_lt_i32 vcc, 1, v29
    ds_add_rtn_u32 v109, v93, v9
    v_cmpx_lt_i32 vcc, 2, v29
    ds_add_rtn_u32 v110, v94, v9
    v_cmpx_lt_i32 vcc, 3, v29
    ds_add_rtn_u32 v111, v95, v9
K2_R3:
    s_mov_b64 exec, -1
    s_lshl_b32 s48, s20, 10
    s_add_u32 m0, s48, 142336
    s_add_u32 s48, s48, 6815744
    buffer_load_dwordx4 v25, s[12:15], s48 offen lds
    s_mov_b32 s34, 6823936
    buffer_load_dwordx4 v[160:163], v25, s[12:15], s34 offen offset:0
    buffer_load_dwordx4 v[164:167], v25, s[12:15], s34 offen offset:1024
    buffer_load_dwordx4 v[168:171], v25, s[12:15], s34 offen offset:2048
    buffer_load_dwordx4 v[172:175], v25, s[12:15], s34 offen offset:3072
    s_waitcnt lgkmcnt(0)
    s_barrier
    s_cmp_ge_u32 s20, 4
    s_cbranch_scc1 K2_NQ3
    v_add_u32 v20, 68608, v20
    v_xor_b32 v21, 16, v20
    v_xor_b32 v22, 32, v20
    v_xor_b32 v23, 48, v20
    ds_read_b128 v[128:131], v20
    ds_read_b128 v[144:147], v20 offset:4096
    ds_read_b128 v[132:135], v21
    ds_read_b128 v[148:151], v21 offset:4096
    ds_read_b128 v[136:139], v22
    ds_read_b128 v[152:155], v22 offset:4096
    ds_read_b128 v[140:143], v23
    ds_read_b128 v[156:159], v23 offset:4096
K2_NQ3:
    v_lshlrev_b32 v4, 2, v1
    v_add_u32 v4, 162816, v4
    ds_read_b32 v5, v4
    ds_read_b32 v7, v4 offset:768
    v_cmp_gt_u32 vcc, s22, v1
    s_waitcnt lgkmcnt(0)
    v_readfirstlane_b32 s50, v7
    v_add_u32 v8, 3, v5
    v_and_b32 v8, -4, v8
    v_max_u32 v8, 32, v8
    v_cndmask_b32 v8, 0, v8, vcc
    v_mov_b32 v21, v8
    v_mov_b32 v12, 0x3fff
    v_mov_b32 v13, 0x7ffffff0
    v_add_u32_dpp v21, v21, v21 row_shr:1 row_mask:0xf bank_mask:0xf bound_ctrl:0
    v_mov_b32 v14, 0
    v_mov_b32 v15, 0
    v_add_u32_dpp v21, v21, v21 row_shr:2 row_mask:0xf bank_mask:0xf bound_ctrl:0
    v_mov_b32 v234, 0x7fffffff
    v_mov_b32 v237, 0x7fffffff
    v_add_u32_dpp v21, v21, v21 row_shr:4 row_mask:0xf bank_mask:0xf bound_ctrl:0
    v_mov_b32 v235, 0
    v_mov_b32 v236, 0
    v_add_u32_dpp v21, v21, v21 row_shr:8 row_mask:0xf bank_mask:0xf bound_ctrl:0
    v_and_b32 v10, 7, v1
    s_nop 0
    v_add_u32_dpp v21, v21, v21 row_bcast:15 row_mask:0xa bank_mask:0xf
    s_nop 1
    v_add_u32_dpp v21, v21, v21 row_bcast:31 row_mask:0xc bank_mask:0xf
    v_sub_u32 v22, v21, v8
    v_lshlrev_b32 v9, 4, v22
    ds_write_b32 v4, v9 offset:256
    v_readlane_b32 s39, v21, 63
    v_cndmask_b32 v234, v234, v22, vcc
    s_mov_b32 s34, 6828032
    buffer_load_dwordx4 v[176:179], v25, s[12:15], s34 offen offset:0
    buffer_load_dwordx4 v[180:183], v25, s[12:15], s34 offen offset:1024
    buffer_load_dwordx4 v[184:187], v25, s[12:15], s34 offen offset:2048
    buffer_load_dwordx4 v[188:191], v25, s[12:15], s34 offen offset:3072
    ds_read_b32 v80, v80 offset:256
    ds_read_b32 v81, v81 offset:256
    ds_read_b32 v82, v82 offset:256
    ds_read_b32 v83, v83 offset:256
    ds_read_b32 v88, v88 offset:256
    ds_read_b32 v89, v89 offset:256
    ds_read_b32 v90, v90 offset:256
    ds_read_b32 v91, v91 offset:256
    ds_read_b32 v84, v84 offset:256
    ds_read_b32 v85, v85 offset:256
    ds_read_b32 v86, v86 offset:256
    ds_read_b32 v87, v87 offset:256
    ds_read_b32 v92, v92 offset:256
    ds_read_b32 v93, v93 offset:256
    ds_read_b32 v94, v94 offset:256
    ds_read_b32 v95, v95 offset:256
    s_mov_b32 s34, 6832128
    buffer_load_dwordx4 v[192:195], v25, s[12:15], s34 offen offset:0
    buffer_load_dwordx4 v[196:199], v25, s[12:15], s34 offen offset:1024
    buffer_load_dwordx4 v[200:203], v25, s[12:15], s34 offen offset:2048
    buffer_load_dwordx4 v[204:207], v25, s[12:15], s34 offen offset:3072
    s_cmp_lg_u32 s20, 0
    s_cbranch_scc1 K2_DG
    ds_write_b32 v4, v5 offset:512
K2_DG:
    s_mov_b32 s38, 1
    s_cmp_gt_u32 s39, 2912
    s_cbranch_scc1 K2_SKIPPL
    s_cmp_lg_u32 s50, 0
    s_cbranch_scc1 K2_SKIPPL
    v_cmp_lt_u32 vcc, 124, v5
    s_cmp_lg_u64 vcc, 0
    s_cbranch_scc1 K2_SKIPPL
    s_add_u32 s46, s39, 31
    s_lshr_b32 s46, s46, 5
    s_lshr_b32 s47, s46, 3
    s_and_b32 s46, s46, 7
    s_mul_i32 s23, s47, s20
    s_min_u32 s48, s46, s20
    s_add_u32 s23, s23, s48
    s_add_u32 s24, s23, s47
    s_cmp_lt_u32 s20, s46
    s_addc_u32 s24, s24, 0
    s_cmp_ge_u32 s20, 2
    s_cbranch_scc1 K2_PTa
    s_lshl_b32 s46, s20, 6
    s_add_u32 s46, s46, s39
    v_add_lshl_u32 v11, s46, v1, 4
    s_cmp_eq_u32 s20, 1
    s_cselect_b32 exec_hi, 0, -1
    ds_write_b128 v11, v[12:15]
    s_mov_b64 exec, -1
K2_PTa:
    v_cmp_eq_u32 vcc, s20, v10
    v_sub_u32 v11, v8, v5
    v_lshl_add_u32 v10, v5, 4, v9
    v_cndmask_b32 v11, 0, v11, vcc
    v_cmpx_lt_i32 vcc, 0, v11
    ds_write_b128 v10, v[12:15] offset:0
    v_cmpx_lt_i32 vcc, 1, v11
    ds_write_b128 v10, v[12:15] offset:16
    v_cmpx_lt_i32 vcc, 2, v11
    ds_write_b128 v10, v[12:15] offset:32
    v_cmpx_lt_i32 vcc, 3, v11
    s_cbranch_execz K2_PEa
    v_add_u32 v10, 48, v10
    v_add_u32 v11, -3, v11
K2_PLa:
    ds_write_b128 v10, v[12:15]
    v_add_u32 v10, 16, v10
    v_add_u32 v11, -1, v11
    v_cmpx_lt_i32 vcc, 0, v11
    s_cbranch_execnz K2_PLa
K2_PEa:
    s_mov_b64 exec, -1
    s_mov_b32 s38, 0
    s_mov_b32 s33, 0
    s_lshl_b32 s46, s23, 9
    v_add_u32 v224, s46, v220
    v_add_u32 v225, s46, v221
    s_lshl_b32 s40, s23, 5
    s_add_u32 s41, s40, 31
    v_cmp_ge_u32 vcc, s41, v234
    s_bcnt1_i32_b64 s42, vcc
    s_sub_u32 s42, s42, 1
    s_max_i32 s42, s42, 0
    v_readlane_b32 s43, v234, s42
    s_sub_u32 s49, s42, 1
    s_max_i32 s49, s49, 0
    s_lshl_b32 s30, s42, 9
    s_sub_i32 s44, s43, s40
    s_lshr_b32 s45, s44, 2
    s_sub_i32 s46, 0, s44
    s_and_b32 s47, s46, 0x60
    s_cselect_b32 s47, 8, 0
    s_cmp_lt_u32 s46, 128
    s_cselect_b32 s47, 8, s47
    s_cmp_ge_i32 s44, 0
    s_cselect_b32 s28, s45, s47
    s_cselect_b32 s49, s49, s42
    s_lshl_b32 s29, s49, 9
    s_bitcmp1_b32 s49, 0
    s_cselect_b32 s31, s30, s29
    s_cselect_b32 s32, s29, s30
    s_mov_b32 s54, s40
    s_movk_i32 s56, 0x200
    s_movk_i32 s57, 0x200
    s_mov_b32 s55, s42
    s_add_u32 s42, s42, 1
    v_readlane_b32 s35, v234, s42
    s_mov_b32 s27, s29
    v_mov_b32_dpp v237, v234 wave_shl:1 row_mask:0xf bank_mask:0xf
    v_add_u32 v226, s31, v222
    v_add_u32 v227, s32, v222
    s_waitcnt lgkmcnt(0)
    v_lshl_add_u32 v80, v96, 4, v80
    v_lshl_add_u32 v81, v97, 4, v81
    v_lshl_add_u32 v82, v98, 4, v82
    v_lshl_add_u32 v83, v99, 4, v83
    v_cmpx_gt_u32 vcc, s51, v32
    ds_write_b128 v80, v[48:51]
    v_cmpx_gt_u32 vcc, s51, v33
    ds_write_b128 v81, v[52:55]
    v_cmpx_gt_u32 vcc, s51, v34
    ds_write_b128 v82, v[56:59]
    v_cmpx_gt_u32 vcc, s51, v35
    ds_write_b128 v83, v[60:63]
    s_mov_b64 exec, -1
    v_lshl_add_u32 v88, v104, 4, v88
    v_lshl_add_u32 v89, v105, 4, v89
    v_lshl_add_u32 v90, v106, 4, v90
    v_lshl_add_u32 v91, v107, 4, v91
    v_cmpx_gt_u32 vcc, s51, v40
    ds_write_b128 v88, v[112:115]
    v_cmpx_gt_u32 vcc, s51, v41
    ds_write_b128 v89, v[116:119]
    v_cmpx_gt_u32 vcc, s51, v42
    ds_write_b128 v90, v[120:123]
    v_cmpx_gt_u32 vcc, s51, v43
    ds_write_b128 v91, v[124:127]
    s_mov_b64 exec, -1
    v_cmpx_lt_i32 vcc, 0, v28
    s_cbranch_execz K2_P1
    v_bfe_i32 v4, v36, 0, 1
    v_bfe_u32 v16, v36, 6, 14
    v_lshrrev_b32 v17, 20, v36
    v_and_b32 v19, v238, v4
    v_lshl_add_u32 v17, v17, 3, v26
    v_xor_b32 v18, v238, v19
    v_lshl_add_u32 v20, v100, 4, v84
    ds_write_b128 v20, v[16:19]
    v_cmpx_lt_i32 vcc, 1, v28
    s_cbranch_execz K2_P1
    v_bfe_i32 v4, v37, 0, 1
    v_bfe_u32 v16, v37, 6, 14
    v_lshrrev_b32 v17, 20, v37
    v_and_b32 v19, v238, v4
    v_lshl_add_u32 v17, v17, 3, v26
    v_xor_b32 v18, v238, v19
    v_lshl_add_u32 v20, v101, 4, v85
    ds_write_b128 v20, v[16:19]
    v_cmpx_lt_i32 vcc, 2, v28
    s_cbranch_execz K2_P1
    v_bfe_i32 v4, v38, 0, 1
    v_bfe_u32 v16, v38, 6, 14
    v_lshrrev_b32 v17, 20, v38
    v_and_b32 v19, v238, v4
    v_lshl_add_u32 v17, v17, 3, v26
    v_xor_b32 v18, v238, v19
    v_lshl_add_u32 v20, v102, 4, v86
    ds_write_b128 v20, v[16:19]
    v_cmpx_lt_i32 vcc, 3, v28
    s_cbranch_execz K2_P1
    v_bfe_i32 v4, v39, 0, 1
    v_bfe_u32 v16, v39, 6, 14
    v_lshrrev_b32 v17, 20, v39
    v_and_b32 v19, v238, v4
    v_lshl_add_u32 v17, v17, 3, v26
    v_xor_b32 v18, v238, v19
    v_lshl_add_u32 v20, v103, 4, v87
    ds_write_b128 v20, v[16:19]
K2_P1:
    s_mov_b64 exec, -1
    v_cmpx_lt_i32 vcc, 0, v29
    s_cbranch_execz K2_P3
    v_bfe_i32 v4, v44, 0, 1
    v_bfe_u32 v16, v44, 6, 14
    v_lshrrev_b32 v17, 20, v44
    v_and_b32 v19, v238, v4
    v_lshl_add_u32 v17, v17, 3, v239
    v_xor_b32 v18, v238, v19
    v_lshl_add_u32 v20, v108, 4, v92
    ds_write_b128 v20, v[16:19]
    v_cmpx_lt_i32 vcc, 1, v29
    s_cbranch_execz K2_P3
    v_bfe_i32 v4, v45, 0, 1
    v_bfe_u32 v16, v45, 6, 14
    v_lshrrev_b32 v17, 20, v45
    v_and_b32 v19, v238, v4
    v_lshl_add_u32 v17, v17, 3, v239
    v_xor_b32 v18, v238, v19
    v_lshl_add_u32 v20, v109, 4, v93
    ds_write_b128 v20, v[16:19]
    v_cmpx_lt_i32 vcc, 2, v29
    s_cbranch_execz K2_P3
    v_bfe_i32 v4, v46, 0, 1
    v_bfe_u32 v16, v46, 6, 14
    v_lshrrev_b32 v17, 20, v46
    v_and_b32 v19, v238, v4
    v_lshl_add_u32 v17, v17, 3, v239
    v_xor_b32 v18, v238, v19
    v_lshl_add_u32 v20, v110, 4, v94
    ds_write_b128 v20, v[16:19]
    v_cmpx_lt_i32 vcc, 3, v29
    s_cbranch_execz K2_P3
    v_bfe_i32 v4, v47, 0, 1
    v_bfe_u32 v16, v47, 6, 14
    v_lshrrev_b32 v17, 20, v47
    v_and_b32 v19, v238, v4
    v_lshl_add_u32 v17, v17, 3, v239
    v_xor_b32 v18, v238, v19
    v_lshl_add_u32 v20, v111, 4, v95
    ds_write_b128 v20, v[16:19]
K2_P3:
    s_mov_b64 exec, -1
K2_SKIPPL:
    s_cmp_ge_u32 s20, 4
    s_cbranch_scc1 K2_QA
    s_waitcnt lgkmcnt(0)
    v_mfma_f32_32x32x16_bf16 v[96:111], v[128:131], v[64:67], 0
    v_mfma_f32_32x32x16_bf16 v[96:111], v[132:135], v[68:71], v[96:111]
    v_mfma_f32_32x32x16_bf16 v[96:111], v[136:139], v[72:75], v[96:111]
    v_mfma_f32_32x32x16_bf16 v[96:111], v[140:143], v[76:79], v[96:111]
    v_mfma_f32_32x32x16_bf16 v[32:47], v[144:147], v[64:67], 0
    v_mfma_f32_32x32x16_bf16 v[32:47], v[148:151], v[68:71], v[32:47]
    v_mfma_f32_32x32x16_bf16 v[32:47], v[152:155], v[72:75], v[32:47]
    v_mfma_f32_32x32x16_bf16 v[32:47], v[156:159], v[76:79], v[32:47]
    s_lshl_b32 s47, s20, 7
    s_add_u32 s47, s47, 48128
    v_lshlrev_b32 v21, 2, v2
    v_lshl_add_u32 v21, v3, 11, v21
    v_add_u32 v21, s47, v21
    v_lshlrev_b32 v24, 16, v24
    s_mov_b32 s50, 0xbf38aa3b
    v_mul_f32 v24, s50, v24
    s_nop 1
    v_fma_f32 v96, v96, s50, v24
    v_fma_f32 v97, v97, s50, v24
    v_fma_f32 v98, v98, s50, v24
    v_fma_f32 v99, v99, s50, v24
    v_and_b32 v64, 0xffff0000, v96
    v_and_b32 v65, 0xffff0000, v97
    v_and_b32 v66, 0xffff0000, v98
    v_and_b32 v67, 0xffff0000, v99
    v_sub_f32 v96, v96, v64
    v_sub_f32 v97, v97, v65
    v_sub_f32 v98, v98, v66
    v_sub_f32 v99, v99, v67
    v_cvt_pk_bf16_f32 v64, v64, v96
    ds_write_b32 v21, v64 offset:0
    v_cvt_pk_bf16_f32 v65, v65, v97
    ds_write_b32 v21, v65 offset:512
    v_cvt_pk_bf16_f32 v66, v66, v98
    ds_write_b32 v21, v66 offset:1024
    v_cvt_pk_bf16_f32 v67, v67, v99
    ds_write_b32 v21, v67 offset:1536
K2_QA:
    s_waitcnt vmcnt(0) lgkmcnt(0)
    s_barrier
    s_cmp_eq_u32 s38, 1
    s_cbranch_scc1 K2_NOGa
    s_cmp_ge_u32 s23, s24
    s_cbranch_scc1 K2_NOGa
    s_mov_b32 m0, s36
    ds_read_b32 v208, v224 offset:0
    ds_read_b32 v210, v224 offset:128
    ds_read_b32 v212, v224 offset:256
    ds_read_b32 v214, v224 offset:384
    ds_read_b128 v[116:119], v225
    v_add_u32 v224, 0x200, v224
    v_add_u32 v225, 0x200, v225
    s_waitcnt lgkmcnt(0)
    buffer_load_dwordx4 v[208:209], s[4:7], 0 idxen offen offset:0 lds
    buffer_load_dwordx4 v[210:211], s[4:7], 0 idxen offen offset:1024 lds
    buffer_load_dwordx4 v[212:213], s[4:7], 0 idxen offen offset:2048 lds
    buffer_load_dwordx4 v[214:215], s[4:7], 0 idxen offen offset:3072 lds
    buffer_load_dwordx2 v[116:117], v117, s[8:11], 0 offen
K2_NOGa:
    s_cmp_lt_u32 s20, 4
    s_cbranch_scc1 K2_QC
    v_add_u32 v27, 142336, v25
    ds_read_b128 v[128:131], v27 offset:0
    ds_read_b128 v[132:135], v27 offset:1024
    ds_read_b128 v[136:139], v27 offset:2048
    ds_read_b128 v[140:143], v27 offset:3072
    ds_read_b128 v[144:147], v27 offset:4096
    ds_read_b128 v[148:151], v27 offset:5120
    ds_read_b128 v[152:155], v27 offset:6144
    ds_read_b128 v[156:159], v27 offset:7168
    s_branch K2_QD
K2_QC:
    v_fma_f32 v100, v100, s50, v24
    v_fma_f32 v101, v101, s50, v24
    v_fma_f32 v102, v102, s50, v24
    v_fma_f32 v103, v103, s50, v24
    v_fma_f32 v104, v104, s50, v24
    v_fma_f32 v105, v105, s50, v24
    v_fma_f32 v106, v106, s50, v24
    v_fma_f32 v107, v107, s50, v24
    v_fma_f32 v108, v108, s50, v24
    v_fma_f32 v109, v109, s50, v24
    v_fma_f32 v110, v110, s50, v24
    v_fma_f32 v111, v111, s50, v24
    v_and_b32 v68, 0xffff0000, v100
    v_and_b32 v69, 0xffff0000, v101
    v_and_b32 v70, 0xffff0000, v102
    v_and_b32 v71, 0xffff0000, v103
    v_and_b32 v72, 0xffff0000, v104
    v_and_b32 v73, 0xffff0000, v105
    v_and_b32 v74, 0xffff0000, v106
    v_and_b32 v75, 0xffff0000, v107
    v_and_b32 v76, 0xffff0000, v108
    v_and_b32 v77, 0xffff0000, v109
    v_and_b32 v78, 0xffff0000, v110
    v_and_b32 v79, 0xffff0000, v111
    v_sub_f32 v100, v100, v68
    v_sub_f32 v101, v101, v69
    v_sub_f32 v102, v102, v70
    v_sub_f32 v103, v103, v71
    v_sub_f32 v104, v104, v72
    v_sub_f32 v105, v105, v73
    v_sub_f32 v106, v106, v74
    v_sub_f32 v107, v107, v75
    v_sub_f32 v108, v108, v76
    v_sub_f32 v109, v109, v77
    v_sub_f32 v110, v110, v78
    v_sub_f32 v111, v111, v79
    v_cvt_pk_bf16_f32 v68, v68, v100
    ds_write_b32 v21, v68 offset:4096
    v_cvt_pk_bf16_f32 v69, v69, v101
    ds_write_b32 v21, v69 offset:4608
    v_cvt_pk_bf16_f32 v70, v70, v102
    ds_write_b32 v21, v70 offset:5120
    v_cvt_pk_bf16_f32 v71, v71, v103
    ds_write_b32 v21, v71 offset:5632
    v_cvt_pk_bf16_f32 v72, v72, v104
    ds_write_b32 v21, v72 offset:8192
    v_cvt_pk_bf16_f32 v73, v73, v105
    ds_write_b32 v21, v73 offset:8704
    v_cvt_pk_bf16_f32 v74, v74, v106
    ds_write_b32 v21, v74 offset:9216
    v_cvt_pk_bf16_f32 v75, v75, v107
    ds_write_b32 v21, v75 offset:9728
    v_cvt_pk_bf16_f32 v76, v76, v108
    ds_write_b32 v21, v76 offset:12288
    v_cvt_pk_bf16_f32 v77, v77, v109
    ds_write_b32 v21, v77 offset:12800
    v_cvt_pk_bf16_f32 v78, v78, v110
    ds_write_b32 v21, v78 offset:13312
    v_cvt_pk_bf16_f32 v79, v79, v111
    ds_write_b32 v21, v79 offset:13824
    v_fma_f32 v32, v32, s50, v24
    v_fma_f32 v33, v33, s50, v24
    v_fma_f32 v34, v34, s50, v24
    v_fma_f32 v35, v35, s50, v24
    v_and_b32 v48, 0xffff0000, v32
    v_and_b32 v49, 0xffff0000, v33
    v_and_b32 v50, 0xffff0000, v34
    v_and_b32 v51, 0xffff0000, v35
    v_sub_f32 v32, v32, v48
    v_sub_f32 v33, v33, v49
    v_sub_f32 v34, v34, v50
    v_sub_f32 v35, v35, v51
    v_cvt_pk_bf16_f32 v48, v48, v32
    ds_write_b32 v21, v48 offset:16384
    v_cvt_pk_bf16_f32 v49, v49, v33
    ds_write_b32 v21, v49 offset:16896
    v_cvt_pk_bf16_f32 v50, v50, v34
    ds_write_b32 v21, v50 offset:17408
    v_cvt_pk_bf16_f32 v51, v51, v35
    ds_write_b32 v21, v51 offset:17920
K2_QD:
    v_mov_b32 v4, 0
    v_mov_b32 v5, 0
    v_pk_mov_b32 v[80:81], v[4:5], v[4:5] op_sel:[0,1]
    v_pk_mov_b32 v[88:89], v[228:229], v[228:229] op_sel:[0,1]
    v_pk_mov_b32 v[82:83], v[4:5], v[4:5] op_sel:[0,1]
    v_pk_mov_b32 v[90:91], v[228:229], v[228:229] op_sel:[0,1]
    v_pk_mov_b32 v[84:85], v[4:5], v[4:5] op_sel:[0,1]
    v_pk_mov_b32 v[92:93], v[228:229], v[228:229] op_sel:[0,1]
    v_pk_mov_b32 v[86:87], v[4:5], v[4:5] op_sel:[0,1]
    v_pk_mov_b32 v[94:95], v[228:229], v[228:229] op_sel:[0,1]
    s_waitcnt lgkmcnt(0)
    s_barrier
    s_cmp_ge_u32 s20, 4
    s_cbranch_scc1 K2_NWR0
    v_add_u32 v27, 142336, v25
    ds_read_b128 v[128:131], v27 offset:0
    ds_read_b128 v[132:135], v27 offset:1024
    ds_read_b128 v[136:139], v27 offset:2048
    ds_read_b128 v[140:143], v27 offset:3072
    ds_read_b128 v[144:147], v27 offset:4096
    ds_read_b128 v[148:151], v27 offset:5120
    ds_read_b128 v[152:155], v27 offset:6144
    ds_read_b128 v[156:159], v27 offset:7168
    s_branch K2_NWR
K2_NWR0:
K2_NWR:
    s_cmp_eq_u32 s38, 1
    s_cbranch_scc1 K2_SLOW
    s_cmp_ge_u32 s23, s24
    s_cbranch_scc1 K2_LOOPDONE
    ds_read_b32 v194, v226 offset:0
    ds_read_b32 v195, v227 offset:0
    ds_read_b32 v198, v226 offset:128
    ds_read_b32 v199, v227 offset:128
    ds_read_b32 v202, v226 offset:256
    ds_read_b32 v203, v227 offset:256
    ds_read_b32 v206, v226 offset:384
    ds_read_b32 v207, v227 offset:384
    ds_read_b32 v208, v224 offset:0
    ds_read_b32 v210, v224 offset:128
    ds_read_b32 v212, v224 offset:256
    ds_read_b32 v214, v224 offset:384
    s_waitcnt vmcnt(0)
    ds_read_b128 v[96:99], v216
    ds_read_b128 v[100:103], v217
    ds_read_b128 v[104:107], v218
    ds_read_b128 v[108:111], v219
    v_pk_mov_b32 v[112:113], v[116:117], v[116:117] op_sel:[0,1]
    v_pk_mov_b32 v[114:115], v[118:119], v[118:119] op_sel:[0,1]
    ds_read_b128 v[116:119], v225
    v_add_u32 v224, 0x200, v224
    v_add_u32 v225, 0x200, v225
    s_waitcnt lgkmcnt(0)
    v_mfma_f32_32x32x16_bf16 v[32:47], v[96:99], v[128:131], 0
    v_mfma_f32_32x32x16_bf16 v[32:47], v[100:103], v[132:135], v[32:47]
    v_mfma_f32_32x32x16_bf16 v[32:47], v[104:107], v[136:139], v[32:47]
    v_mfma_f32_32x32x16_bf16 v[32:47], v[108:111], v[140:143], v[32:47]
    v_mfma_f32_32x32x16_bf16 v[32:47], v[112:115], v[192:195], v[32:47]
    buffer_load_dwordx4 v[208:209], s[4:7], 0 idxen offen offset:0 lds
    buffer_load_dwordx4 v[210:211], s[4:7], 0 idxen offen offset:1024 lds
    buffer_load_dwordx4 v[212:213], s[4:7], 0 idxen offen offset:2048 lds
    buffer_load_dwordx4 v[214:215], s[4:7], 0 idxen offen offset:3072 lds
    buffer_load_dwordx2 v[116:117], v117, s[8:11], 0 offen
    s_lshl_b32 s24, s24, 5
K2_DISP:
    s_cmp_lg_u32 s28, 8
    s_cbranch_scc1 K2_DO
    .p2align 6
K2_V8:
    s_mov_b32 s27, s30
    v_mfma_f32_32x32x16_bf16 v[48:63], v[96:99], v[144:147], 0
    v_exp_f32 v64, v32
    v_exp_f32 v65, v33
    v_exp_f32 v66, v34
    v_mfma_f32_32x32x16_bf16 v[48:63], v[100:103], v[148:151], v[48:63]
    v_exp_f32 v67, v35
    v_exp_f32 v68, v36
    v_exp_f32 v69, v37
    v_mfma_f32_32x32x16_bf16 v[48:63], v[104:107], v[152:155], v[48:63]
    v_exp_f32 v70, v38
    v_exp_f32 v71, v39
    v_exp_f32 v72, v40
    v_mfma_f32_32x32x16_bf16 v[48:63], v[108:111], v[156:159], v[48:63]
    v_exp_f32 v73, v41
    v_exp_f32 v74, v42
    v_exp_f32 v75, v43
    v_mfma_f32_32x32x16_bf16 v[48:63], v[112:115], v[196:199], v[48:63]
    v_exp_f32 v76, v44
    v_exp_f32 v77, v45
    v_exp_f32 v78, v46
    v_exp_f32 v79, v47
    v_pk_fma_f32 v[80:81], v[80:81], v[64:65], v[80:81]
    s_add_u32 s54, s54, 32
    v_pk_fma_f32 v[120:121], v[88:89], v[64:65], v[88:89]
    s_sub_i32 s44, s35, s54
    v_pk_fma_f32 v[80:81], v[32:33], v[88:89], v[80:81]
    s_lshr_b32 s45, s44, 2
    v_pk_fma_f32 v[80:81], v[80:81], v[66:67], v[80:81]
    s_cmp_lt_i32 s44, 32
    v_pk_fma_f32 v[88:89], v[120:121], v[66:67], v[120:121]
    s_cselect_b32 s28, s45, 8
    v_pk_fma_f32 v[80:81], v[34:35], v[120:121], v[80:81]
    s_addc_u32 s55, s55, 0
    v_pk_fma_f32 v[80:81], v[80:81], v[68:69], v[80:81]
    s_lshl_b32 s30, s55, 9
    v_pk_fma_f32 v[120:121], v[88:89], v[68:69], v[88:89]
    v_readlane_b32 s35, v237, s55
    v_pk_fma_f32 v[80:81], v[36:37], v[88:89], v[80:81]
    v_pk_fma_f32 v[80:81], v[80:81], v[70:71], v[80:81]
    v_pk_fma_f32 v[88:89], v[120:121], v[70:71], v[120:121]
    v_pk_fma_f32 v[80:81], v[38:39], v[120:121], v[80:81]
    v_pk_fma_f32 v[80:81], v[80:81], v[72:73], v[80:81]
    v_pk_fma_f32 v[120:121], v[88:89], v[72:73], v[88:89]
    v_pk_fma_f32 v[80:81], v[40:41], v[88:89], v[80:81]
    v_pk_fma_f32 v[80:81], v[80:81], v[74:75], v[80:81]
    v_pk_fma_f32 v[88:89], v[120:121], v[74:75], v[120:121]
    v_pk_fma_f32 v[80:81], v[42:43], v[120:121], v[80:81]
    v_pk_fma_f32 v[80:81], v[80:81], v[76:77], v[80:81]
    v_pk_fma_f32 v[120:121], v[88:89], v[76:77], v[88:89]
    v_pk_fma_f32 v[80:81], v[44:45], v[88:89], v[80:81]
    v_pk_fma_f32 v[80:81], v[80:81], v[78:79], v[80:81]
    v_pk_fma_f32 v[88:89], v[120:121], v[78:79], v[120:121]
    v_pk_fma_f32 v[80:81], v[46:47], v[120:121], v[80:81]
    v_mfma_f32_32x32x16_bf16 v[32:47], v[96:99], v[160:163], 0
    v_exp_f32 v64, v48
    v_exp_f32 v65, v49
    v_exp_f32 v66, v50
    v_mfma_f32_32x32x16_bf16 v[32:47], v[100:103], v[164:167], v[32:47]
    v_exp_f32 v67, v51
    v_exp_f32 v68, v52
    v_exp_f32 v69, v53
    v_mfma_f32_32x32x16_bf16 v[32:47], v[104:107], v[168:171], v[32:47]
    v_exp_f32 v70, v54
    v_exp_f32 v71, v55
    v_exp_f32 v72, v56
    v_mfma_f32_32x32x16_bf16 v[32:47], v[108:111], v[172:175], v[32:47]
    v_exp_f32 v73, v57
    v_exp_f32 v74, v58
    v_exp_f32 v75, v59
    v_mfma_f32_32x32x16_bf16 v[32:47], v[112:115], v[200:203], v[32:47]
    v_exp_f32 v76, v60
    v_exp_f32 v77, v61
    v_exp_f32 v78, v62
    v_exp_f32 v79, v63
    v_pk_fma_f32 v[82:83], v[82:83], v[64:65], v[82:83]
    v_pk_fma_f32 v[120:121], v[90:91], v[64:65], v[90:91]
    v_pk_fma_f32 v[82:83], v[48:49], v[90:91], v[82:83]
    v_pk_fma_f32 v[82:83], v[82:83], v[66:67], v[82:83]
    v_pk_fma_f32 v[90:91], v[120:121], v[66:67], v[120:121]
    v_pk_fma_f32 v[82:83], v[50:51], v[120:121], v[82:83]
    v_pk_fma_f32 v[82:83], v[82:83], v[68:69], v[82:83]
    v_pk_fma_f32 v[120:121], v[90:91], v[68:69], v[90:91]
    v_pk_fma_f32 v[82:83], v[52:53], v[90:91], v[82:83]
    v_pk_fma_f32 v[82:83], v[82:83], v[70:71], v[82:83]
    v_pk_fma_f32 v[90:91], v[120:121], v[70:71], v[120:121]
    v_pk_fma_f32 v[82:83], v[54:55], v[120:121], v[82:83]
    v_pk_fma_f32 v[82:83], v[82:83], v[72:73], v[82:83]
    v_pk_fma_f32 v[120:121], v[90:91], v[72:73], v[90:91]
    v_pk_fma_f32 v[82:83], v[56:57], v[90:91], v[82:83]
    v_pk_fma_f32 v[82:83], v[82:83], v[74:75], v[82:83]
    v_pk_fma_f32 v[90:91], v[120:121], v[74:75], v[120:121]
    v_pk_fma_f32 v[82:83], v[58:59], v[120:121], v[82:83]
    v_pk_fma_f32 v[82:83], v[82:83], v[76:77], v[82:83]
    v_pk_fma_f32 v[120:121], v[90:91], v[76:77], v[90:91]
    v_pk_fma_f32 v[82:83], v[60:61], v[90:91], v[82:83]
    v_pk_fma_f32 v[82:83], v[82:83], v[78:79], v[82:83]
    v_pk_fma_f32 v[90:91], v[120:121], v[78:79], v[120:121]
    v_pk_fma_f32 v[82:83], v[62:63], v[120:121], v[82:83]
    v_mfma_f32_32x32x16_bf16 v[48:63], v[96:99], v[176:179], 0
    v_exp_f32 v64, v32
    v_exp_f32 v65, v33
    v_exp_f32 v66, v34
    v_mfma_f32_32x32x16_bf16 v[48:63], v[100:103], v[180:183], v[48:63]
    v_exp_f32 v67, v35
    v_exp_f32 v68, v36
    v_exp_f32 v69, v37
    v_mfma_f32_32x32x16_bf16 v[48:63], v[104:107], v[184:187], v[48:63]
    v_exp_f32 v70, v38
    v_exp_f32 v71, v39
    v_exp_f32 v72, v40
    v_mfma_f32_32x32x16_bf16 v[48:63], v[108:111], v[188:191], v[48:63]
    v_exp_f32 v73, v41
    v_exp_f32 v74, v42
    v_exp_f32 v75, v43
    v_mfma_f32_32x32x16_bf16 v[48:63], v[112:115], v[204:207], v[48:63]
    v_exp_f32 v76, v44
    v_exp_f32 v77, v45
    v_exp_f32 v78, v46
    v_exp_f32 v79, v47
    s_waitcnt vmcnt(0)
    ds_read_b128 v[96:99], v216
    ds_read_b128 v[100:103], v217
    ds_read_b128 v[104:107], v218
    ds_read_b128 v[108:111], v219
    v_pk_mov_b32 v[112:113], v[116:117], v[116:117] op_sel:[0,1]
    v_pk_mov_b32 v[114:115], v[118:119], v[118:119] op_sel:[0,1]
    ds_read_b128 v[116:119], v225
    ds_read_b32 v208, v224 offset:0
    ds_read_b32 v210, v224 offset:128
    ds_read_b32 v212, v224 offset:256
    ds_read_b32 v214, v224 offset:384
    ds_read_b32 v232, v230
    s_cmp_eq_u32 s28, 8
    s_cbranch_scc1 K2_NQv8
    v_add_u32 v226, s30, v222
    s_bitcmp1_b32 s30, 9
    s_cbranch_scc1 K2_OQv8
    ds_read_b32 v194, v226 offset:0
    ds_read_b32 v198, v226 offset:128
    ds_read_b32 v202, v226 offset:256
    ds_read_b32 v206, v226 offset:384
    s_branch K2_NQv8
K2_OQv8:
    ds_read_b32 v195, v226 offset:0
    ds_read_b32 v199, v226 offset:128
    ds_read_b32 v203, v226 offset:256
    ds_read_b32 v207, v226 offset:384
K2_NQv8:
    v_lshl_add_u64 v[224:225], v[224:225], 0, s[56:57]
    v_pk_fma_f32 v[84:85], v[84:85], v[64:65], v[84:85]
    v_pk_fma_f32 v[120:121], v[92:93], v[64:65], v[92:93]
    v_pk_fma_f32 v[84:85], v[32:33], v[92:93], v[84:85]
    v_pk_fma_f32 v[84:85], v[84:85], v[66:67], v[84:85]
    v_pk_fma_f32 v[92:93], v[120:121], v[66:67], v[120:121]
    v_pk_fma_f32 v[84:85], v[34:35], v[120:121], v[84:85]
    v_pk_fma_f32 v[84:85], v[84:85], v[68:69], v[84:85]
    v_pk_fma_f32 v[120:121], v[92:93], v[68:69], v[92:93]
    v_pk_fma_f32 v[84:85], v[36:37], v[92:93], v[84:85]
    v_pk_fma_f32 v[84:85], v[84:85], v[70:71], v[84:85]
    v_pk_fma_f32 v[92:93], v[120:121], v[70:71], v[120:121]
    v_pk_fma_f32 v[84:85], v[38:39], v[120:121], v[84:85]
    v_pk_fma_f32 v[84:85], v[84:85], v[72:73], v[84:85]
    v_pk_fma_f32 v[120:121], v[92:93], v[72:73], v[92:93]
    v_pk_fma_f32 v[84:85], v[40:41], v[92:93], v[84:85]
    v_pk_fma_f32 v[84:85], v[84:85], v[74:75], v[84:85]
    v_pk_fma_f32 v[92:93], v[120:121], v[74:75], v[120:121]
    v_pk_fma_f32 v[84:85], v[42:43], v[120:121], v[84:85]
    v_pk_fma_f32 v[84:85], v[84:85], v[76:77], v[84:85]
    v_pk_fma_f32 v[120:121], v[92:93], v[76:77], v[92:93]
    v_pk_fma_f32 v[84:85], v[44:45], v[92:93], v[84:85]
    v_pk_fma_f32 v[84:85], v[84:85], v[78:79], v[84:85]
    v_pk_fma_f32 v[92:93], v[120:121], v[78:79], v[120:121]
    v_pk_fma_f32 v[84:85], v[46:47], v[120:121], v[84:85]
    s_waitcnt lgkmcnt(0)
    v_add_u32 v236, 1, v236
    buffer_load_dwordx4 v[208:209], s[4:7], 0 idxen offen offset:0 lds
    buffer_load_dwordx4 v[210:211], s[4:7], 0 idxen offen offset:1024 lds
    ds_write_b32 v231, v236
    v_cmp_gt_u32 vcc, v236, v232
    buffer_load_dwordx4 v[212:213], s[4:7], 0 idxen offen offset:2048 lds
    buffer_load_dwordx4 v[214:215], s[4:7], 0 idxen offen offset:3072 lds
    buffer_load_dwordx2 v[116:117], v117, s[8:11], 0 offen
    s_setprio 0
    s_cbranch_vccnz K2_PDv8
    s_setprio 1
K2_PDv8:
    v_mfma_f32_32x32x16_bf16 v[32:47], v[96:99], v[128:131], 0
    v_exp_f32 v64, v48
    v_exp_f32 v65, v49
    v_exp_f32 v66, v50
    v_mfma_f32_32x32x16_bf16 v[32:47], v[100:103], v[132:135], v[32:47]
    v_exp_f32 v67, v51
    v_exp_f32 v68, v52
    v_exp_f32 v69, v53
    v_mfma_f32_32x32x16_bf16 v[32:47], v[104:107], v[136:139], v[32:47]
    v_exp_f32 v70, v54
    v_exp_f32 v71, v55
    v_exp_f32 v72, v56
    v_mfma_f32_32x32x16_bf16 v[32:47], v[108:111], v[140:143], v[32:47]
    v_exp_f32 v73, v57
    v_exp_f32 v74, v58
    v_exp_f32 v75, v59
    v_mfma_f32_32x32x16_bf16 v[32:47], v[112:115], v[192:195], v[32:47]
    v_exp_f32 v76, v60
    v_exp_f32 v77, v61
    v_exp_f32 v78, v62
    v_exp_f32 v79, v63
    v_pk_fma_f32 v[86:87], v[86:87], v[64:65], v[86:87]
    v_pk_fma_f32 v[120:121], v[94:95], v[64:65], v[94:95]
    v_pk_fma_f32 v[86:87], v[48:49], v[94:95], v[86:87]
    v_pk_fma_f32 v[86:87], v[86:87], v[66:67], v[86:87]
    v_pk_fma_f32 v[94:95], v[120:121], v[66:67], v[120:121]
    v_pk_fma_f32 v[86:87], v[50:51], v[120:121], v[86:87]
    v_pk_fma_f32 v[86:87], v[86:87], v[68:69], v[86:87]
    v_pk_fma_f32 v[120:121], v[94:95], v[68:69], v[94:95]
    v_pk_fma_f32 v[86:87], v[52:53], v[94:95], v[86:87]
    v_pk_fma_f32 v[86:87], v[86:87], v[70:71], v[86:87]
    v_pk_fma_f32 v[94:95], v[120:121], v[70:71], v[120:121]
    v_pk_fma_f32 v[86:87], v[54:55], v[120:121], v[86:87]
    v_pk_fma_f32 v[86:87], v[86:87], v[72:73], v[86:87]
    v_pk_fma_f32 v[120:121], v[94:95], v[72:73], v[94:95]
    v_pk_fma_f32 v[86:87], v[56:57], v[94:95], v[86:87]
    v_pk_fma_f32 v[86:87], v[86:87], v[74:75], v[86:87]
    v_pk_fma_f32 v[94:95], v[120:121], v[74:75], v[120:121]
    v_pk_fma_f32 v[86:87], v[58:59], v[120:121], v[86:87]
    v_pk_fma_f32 v[86:87], v[86:87], v[76:77], v[86:87]
    v_pk_fma_f32 v[120:121], v[94:95], v[76:77], v[94:95]
    v_pk_fma_f32 v[86:87], v[60:61], v[94:95], v[86:87]
    v_pk_fma_f32 v[86:87], v[86:87], v[78:79], v[86:87]
    v_pk_fma_f32 v[94:95], v[120:121], v[78:79], v[120:121]
    v_pk_fma_f32 v[86:87], v[62:63], v[120:121], v[86:87]
    s_cmp_ge_u32 s54, s24
    s_cbranch_scc1 K2_FLUSH
    s_cmp_eq_u32 s28, 8
    s_cbranch_scc1 K2_V8
    s_branch K2_DO
K2_DO:
    s_cmp_lt_u32 s28, 4
    s_cbranch_scc1 K2_DL
    s_cmp_lt_u32 s28, 6
    s_cbranch_scc1 K2_D45
    s_cmp_eq_u32 s28, 6
    s_cbranch_scc1 K2_V6
    .p2align 6
K2_V7:
    v_lshl_add_u32 v233, s27, 1, v223
    s_mov_b32 s27, s30
    v_mfma_f32_32x32x16_bf16 v[48:63], v[96:99], v[144:147], 0
    v_exp_f32 v64, v32
    v_exp_f32 v65, v33
    v_exp_f32 v66, v34
    v_mfma_f32_32x32x16_bf16 v[48:63], v[100:103], v[148:151], v[48:63]
    v_exp_f32 v67, v35
    v_exp_f32 v68, v36
    v_exp_f32 v69, v37
    v_mfma_f32_32x32x16_bf16 v[48:63], v[104:107], v[152:155], v[48:63]
    v_exp_f32 v70, v38
    v_exp_f32 v71, v39
    v_exp_f32 v72, v40
    v_mfma_f32_32x32x16_bf16 v[48:63], v[108:111], v[156:159], v[48:63]
    v_exp_f32 v73, v41
    v_exp_f32 v74, v42
    v_exp_f32 v75, v43
    v_mfma_f32_32x32x16_bf16 v[48:63], v[112:115], v[196:199], v[48:63]
    v_exp_f32 v76, v44
    v_exp_f32 v77, v45
    v_exp_f32 v78, v46
    v_exp_f32 v79, v47
    v_pk_fma_f32 v[80:81], v[80:81], v[64:65], v[80:81]
    s_add_u32 s54, s54, 32
    v_pk_fma_f32 v[120:121], v[88:89], v[64:65], v[88:89]
    s_sub_i32 s44, s35, s54
    v_pk_fma_f32 v[80:81], v[32:33], v[88:89], v[80:81]
    s_lshr_b32 s45, s44, 2
    v_pk_fma_f32 v[80:81], v[80:81], v[66:67], v[80:81]
    s_cmp_lt_i32 s44, 32
    v_pk_fma_f32 v[88:89], v[120:121], v[66:67], v[120:121]
    s_cselect_b32 s28, s45, 8
    v_pk_fma_f32 v[80:81], v[34:35], v[120:121], v[80:81]
    s_addc_u32 s55, s55, 0
    v_pk_fma_f32 v[80:81], v[80:81], v[68:69], v[80:81]
    s_lshl_b32 s30, s55, 9
    v_pk_fma_f32 v[120:121], v[88:89], v[68:69], v[88:89]
    v_readlane_b32 s35, v237, s55
    v_pk_fma_f32 v[80:81], v[36:37], v[88:89], v[80:81]
    v_pk_fma_f32 v[80:81], v[80:81], v[70:71], v[80:81]
    v_pk_fma_f32 v[88:89], v[120:121], v[70:71], v[120:121]
    v_pk_fma_f32 v[80:81], v[38:39], v[120:121], v[80:81]
    v_pk_fma_f32 v[80:81], v[80:81], v[72:73], v[80:81]
    v_pk_fma_f32 v[120:121], v[88:89], v[72:73], v[88:89]
    v_pk_fma_f32 v[80:81], v[40:41], v[88:89], v[80:81]
    v_pk_fma_f32 v[80:81], v[80:81], v[74:75], v[80:81]
    v_pk_fma_f32 v[88:89], v[120:121], v[74:75], v[120:121]
    v_pk_fma_f32 v[80:81], v[42:43], v[120:121], v[80:81]
    v_pk_fma_f32 v[80:81], v[80:81], v[76:77], v[80:81]
    v_pk_fma_f32 v[120:121], v[88:89], v[76:77], v[88:89]
    v_pk_fma_f32 v[80:81], v[44:45], v[88:89], v[80:81]
    v_rcp_f32 v122, v120
    v_rcp_f32 v123, v121
    v_max3_f32 v235, v235, v120, v121
    v_pk_add_f32 v[88:89], v[78:79], v[228:229]
    v_pk_mul_f32 v[124:125], v[80:81], v[122:123]
    v_add_f32 v127, v124, v125
    v_cvt_f64_f32 v[124:125], v127
    ds_add_f64 v233, v[124:125] offset:0
    v_pk_mov_b32 v[80:81], v[46:47], v[46:47] op_sel:[0,1]
    v_mfma_f32_32x32x16_bf16 v[32:47], v[96:99], v[160:163], 0
    v_exp_f32 v64, v48
    v_exp_f32 v65, v49
    v_exp_f32 v66, v50
    v_mfma_f32_32x32x16_bf16 v[32:47], v[100:103], v[164:167], v[32:47]
    v_exp_f32 v67, v51
    v_exp_f32 v68, v52
    v_exp_f32 v69, v53
    v_mfma_f32_32x32x16_bf16 v[32:47], v[104:107], v[168:171], v[32:47]
    v_exp_f32 v70, v54
    v_exp_f32 v71, v55
    v_exp_f32 v72, v56
    v_mfma_f32_32x32x16_bf16 v[32:47], v[108:111], v[172:175], v[32:47]
    v_exp_f32 v73, v57
    v_exp_f32 v74, v58
    v_exp_f32 v75, v59
    v_mfma_f32_32x32x16_bf16 v[32:47], v[112:115], v[200:203], v[32:47]
    v_exp_f32 v76, v60
    v_exp_f32 v77, v61
    v_exp_f32 v78, v62
    v_exp_f32 v79, v63
    v_pk_fma_f32 v[82:83], v[82:83], v[64:65], v[82:83]
    v_pk_fma_f32 v[120:121], v[90:91], v[64:65], v[90:91]
    v_pk_fma_f32 v[82:83], v[48:49], v[90:91], v[82:83]
    v_pk_fma_f32 v[82:83], v[82:83], v[66:67], v[82:83]
    v_pk_fma_f32 v[90:91], v[120:121], v[66:67], v[120:121]
    v_pk_fma_f32 v[82:83], v[50:51], v[120:121], v[82:83]
    v_pk_fma_f32 v[82:83], v[82:83], v[68:69], v[82:83]
    v_pk_fma_f32 v[120:121], v[90:91], v[68:69], v[90:91]
    v_pk_fma_f32 v[82:83], v[52:53], v[90:91], v[82:83]
    v_pk_fma_f32 v[82:83], v[82:83], v[70:71], v[82:83]
    v_pk_fma_f32 v[90:91], v[120:121], v[70:71], v[120:121]
    v_pk_fma_f32 v[82:83], v[54:55], v[120:121], v[82:83]
    v_pk_fma_f32 v[82:83], v[82:83], v[72:73], v[82:83]
    v_pk_fma_f32 v[120:121], v[90:91], v[72:73], v[90:91]
    v_pk_fma_f32 v[82:83], v[56:57], v[90:91], v[82:83]
    v_pk_fma_f32 v[82:83], v[82:83], v[74:75], v[82:83]
    v_pk_fma_f32 v[90:91], v[120:121], v[74:75], v[120:121]
    v_pk_fma_f32 v[82:83], v[58:59], v[120:121], v[82:83]
    v_pk_fma_f32 v[82:83], v[82:83], v[76:77], v[82:83]
    v_pk_fma_f32 v[120:121], v[90:91], v[76:77], v[90:91]
    v_pk_fma_f32 v[82:83], v[60:61], v[90:91], v[82:83]
    v_rcp_f32 v122, v120
    v_rcp_f32 v123, v121
    v_max3_f32 v235, v235, v120, v121
    v_pk_add_f32 v[90:91], v[78:79], v[228:229]
    v_pk_mul_f32 v[124:125], v[82:83], v[122:123]
    v_add_f32 v127, v124, v125
    v_cvt_f64_f32 v[124:125], v127
    ds_add_f64 v233, v[124:125] offset:256
    v_pk_mov_b32 v[82:83], v[62:63], v[62:63] op_sel:[0,1]
    v_mfma_f32_32x32x16_bf16 v[48:63], v[96:99], v[176:179], 0
    v_exp_f32 v64, v32
    v_exp_f32 v65, v33
    v_exp_f32 v66, v34
    v_mfma_f32_32x32x16_bf16 v[48:63], v[100:103], v[180:183], v[48:63]
    v_exp_f32 v67, v35
    v_exp_f32 v68, v36
    v_exp_f32 v69, v37
    v_mfma_f32_32x32x16_bf16 v[48:63], v[104:107], v[184:187], v[48:63]
    v_exp_f32 v70, v38
    v_exp_f32 v71, v39
    v_exp_f32 v72, v40
    v_mfma_f32_32x32x16_bf16 v[48:63], v[108:111], v[188:191], v[48:63]
    v_exp_f32 v73, v41
    v_exp_f32 v74, v42
    v_exp_f32 v75, v43
    v_mfma_f32_32x32x16_bf16 v[48:63], v[112:115], v[204:207], v[48:63]
    v_exp_f32 v76, v44
    v_exp_f32 v77, v45
    v_exp_f32 v78, v46
    v_exp_f32 v79, v47
    s_waitcnt vmcnt(0)
    ds_read_b128 v[96:99], v216
    ds_read_b128 v[100:103], v217
    ds_read_b128 v[104:107], v218
    ds_read_b128 v[108:111], v219
    v_pk_mov_b32 v[112:113], v[116:117], v[116:117] op_sel:[0,1]
    v_pk_mov_b32 v[114:115], v[118:119], v[118:119] op_sel:[0,1]
    ds_read_b128 v[116:119], v225
    ds_read_b32 v208, v224 offset:0
    ds_read_b32 v210, v224 offset:128
    ds_read_b32 v212, v224 offset:256
    ds_read_b32 v214, v224 offset:384
    ds_read_b32 v232, v230
    s_cmp_eq_u32 s28, 8
    s_cbranch_scc1 K2_NQv7
    v_add_u32 v226, s30, v222
    s_bitcmp1_b32 s30, 9
    s_cbranch_scc1 K2_OQv7
    ds_read_b32 v194, v226 offset:0
    ds_read_b32 v198, v226 offset:128
    ds_read_b32 v202, v226 offset:256
    ds_read_b32 v206, v226 offset:384
    s_branch K2_NQv7
K2_OQv7:
    ds_read_b32 v195, v226 offset:0
    ds_read_b32 v199, v226 offset:128
    ds_read_b32 v203, v226 offset:256
    ds_read_b32 v207, v226 offset:384
K2_NQv7:
    v_lshl_add_u64 v[224:225], v[224:225], 0, s[56:57]
    v_pk_fma_f32 v[84:85], v[84:85], v[64:65], v[84:85]
    v_pk_fma_f32 v[120:121], v[92:93], v[64:65], v[92:93]
    v_pk_fma_f32 v[84:85], v[32:33], v[92:93], v[84:85]
    v_pk_fma_f32 v[84:85], v[84:85], v[66:67], v[84:85]
    v_pk_fma_f32 v[92:93], v[120:121], v[66:67], v[120:121]
    v_pk_fma_f32 v[84:85], v[34:35], v[120:121], v[84:85]
    v_pk_fma_f32 v[84:85], v[84:85], v[68:69], v[84:85]
    v_pk_fma_f32 v[120:121], v[92:93], v[68:69], v[92:93]
    v_pk_fma_f32 v[84:85], v[36:37], v[92:93], v[84:85]
    v_pk_fma_f32 v[84:85], v[84:85], v[70:71], v[84:85]
    v_pk_fma_f32 v[92:93], v[120:121], v[70:71], v[120:121]
    v_pk_fma_f32 v[84:85], v[38:39], v[120:121], v[84:85]
    v_pk_fma_f32 v[84:85], v[84:85], v[72:73], v[84:85]
    v_pk_fma_f32 v[120:121], v[92:93], v[72:73], v[92:93]
    v_pk_fma_f32 v[84:85], v[40:41], v[92:93], v[84:85]
    v_pk_fma_f32 v[84:85], v[84:85], v[74:75], v[84:85]
    v_pk_fma_f32 v[92:93], v[120:121], v[74:75], v[120:121]
    v_pk_fma_f32 v[84:85], v[42:43], v[120:121], v[84:85]
    v_pk_fma_f32 v[84:85], v[84:85], v[76:77], v[84:85]
    v_pk_fma_f32 v[120:121], v[92:93], v[76:77], v[92:93]
    v_pk_fma_f32 v[84:85], v[44:45], v[92:93], v[84:85]
    v_rcp_f32 v122, v120
    v_rcp_f32 v123, v121
    v_max3_f32 v235, v235, v120, v121
    v_pk_add_f32 v[92:93], v[78:79], v[228:229]
    v_pk_mul_f32 v[124:125], v[84:85], v[122:123]
    v_add_f32 v127, v124, v125
    v_cvt_f64_f32 v[124:125], v127
    ds_add_f64 v233, v[124:125] offset:512
    v_pk_mov_b32 v[84:85], v[46:47], v[46:47] op_sel:[0,1]
    s_waitcnt lgkmcnt(0)
    v_add_u32 v236, 1, v236
    buffer_load_dwordx4 v[208:209], s[4:7], 0 idxen offen offset:0 lds
    buffer_load_dwordx4 v[210:211], s[4:7], 0 idxen offen offset:1024 lds
    ds_write_b32 v231, v236
    v_cmp_gt_u32 vcc, v236, v232
    buffer_load_dwordx4 v[212:213], s[4:7], 0 idxen offen offset:2048 lds
    buffer_load_dwordx4 v[214:215], s[4:7], 0 idxen offen offset:3072 lds
    buffer_load_dwordx2 v[116:117], v117, s[8:11], 0 offen
    s_setprio 0
    s_cbranch_vccnz K2_PDv7
    s_setprio 1
K2_PDv7:
    v_mfma_f32_32x32x16_bf16 v[32:47], v[96:99], v[128:131], 0
    v_exp_f32 v64, v48
    v_exp_f32 v65, v49
    v_exp_f32 v66, v50
    v_mfma_f32_32x32x16_bf16 v[32:47], v[100:103], v[132:135], v[32:47]
    v_exp_f32 v67, v51
    v_exp_f32 v68, v52
    v_exp_f32 v69, v53
    v_mfma_f32_32x32x16_bf16 v[32:47], v[104:107], v[136:139], v[32:47]
    v_exp_f32 v70, v54
    v_exp_f32 v71, v55
    v_exp_f32 v72, v56
    v_mfma_f32_32x32x16_bf16 v[32:47], v[108:111], v[140:143], v[32:47]
    v_exp_f32 v73, v57
    v_exp_f32 v74, v58
    v_exp_f32 v75, v59
    v_mfma_f32_32x32x16_bf16 v[32:47], v[112:115], v[192:195], v[32:47]
    v_exp_f32 v76, v60
    v_exp_f32 v77, v61
    v_exp_f32 v78, v62
    v_exp_f32 v79, v63
    v_pk_fma_f32 v[86:87], v[86:87], v[64:65], v[86:87]
    v_pk_fma_f32 v[120:121], v[94:95], v[64:65], v[94:95]
    v_pk_fma_f32 v[86:87], v[48:49], v[94:95], v[86:87]
    v_pk_fma_f32 v[86:87], v[86:87], v[66:67], v[86:87]
    v_pk_fma_f32 v[94:95], v[120:121], v[66:67], v[120:121]
    v_pk_fma_f32 v[86:87], v[50:51], v[120:121], v[86:87]
    v_pk_fma_f32 v[86:87], v[86:87], v[68:69], v[86:87]
    v_pk_fma_f32 v[120:121], v[94:95], v[68:69], v[94:95]
    v_pk_fma_f32 v[86:87], v[52:53], v[94:95], v[86:87]
    v_pk_fma_f32 v[86:87], v[86:87], v[70:71], v[86:87]
    v_pk_fma_f32 v[94:95], v[120:121], v[70:71], v[120:121]
    v_pk_fma_f32 v[86:87], v[54:55], v[120:121], v[86:87]
    v_pk_fma_f32 v[86:87], v[86:87], v[72:73], v[86:87]
    v_pk_fma_f32 v[120:121], v[94:95], v[72:73], v[94:95]
    v_pk_fma_f32 v[86:87], v[56:57], v[94:95], v[86:87]
    v_pk_fma_f32 v[86:87], v[86:87], v[74:75], v[86:87]
    v_pk_fma_f32 v[94:95], v[120:121], v[74:75], v[120:121]
    v_pk_fma_f32 v[86:87], v[58:59], v[120:121], v[86:87]
    v_pk_fma_f32 v[86:87], v[86:87], v[76:77], v[86:87]
    v_pk_fma_f32 v[120:121], v[94:95], v[76:77], v[94:95]
    v_pk_fma_f32 v[86:87], v[60:61], v[94:95], v[86:87]
    v_rcp_f32 v122, v120
    v_rcp_f32 v123, v121
    v_max3_f32 v235, v235, v120, v121
    v_pk_add_f32 v[94:95], v[78:79], v[228:229]
    v_pk_mul_f32 v[124:125], v[86:87], v[122:123]
    v_add_f32 v127, v124, v125
    v_cvt_f64_f32 v[124:125], v127
    ds_add_f64 v233, v[124:125] offset:768
    v_pk_mov_b32 v[86:87], v[62:63], v[62:63] op_sel:[0,1]
    s_cmp_ge_u32 s54, s24
    s_cbranch_scc1 K2_FLUSH
    s_cmp_eq_u32 s28, 8
    s_cbranch_scc1 K2_V8
    s_branch K2_DO
K2_D45:
    s_cmp_eq_u32 s28, 4
    s_cbranch_scc1 K2_V4
    .p2align 6
K2_V5:
    v_lshl_add_u32 v233, s27, 1, v223
    s_mov_b32 s27, s30
    v_mfma_f32_32x32x16_bf16 v[48:63], v[96:99], v[144:147], 0
    v_exp_f32 v64, v32
    v_exp_f32 v65, v33
    v_exp_f32 v66, v34
    v_mfma_f32_32x32x16_bf16 v[48:63], v[100:103], v[148:151], v[48:63]
    v_exp_f32 v67, v35
    v_exp_f32 v68, v36
    v_exp_f32 v69, v37
    v_mfma_f32_32x32x16_bf16 v[48:63], v[104:107], v[152:155], v[48:63]
    v_exp_f32 v70, v38
    v_exp_f32 v71, v39
    v_exp_f32 v72, v40
    v_mfma_f32_32x32x16_bf16 v[48:63], v[108:111], v[156:159], v[48:63]
    v_exp_f32 v73, v41
    v_exp_f32 v74, v42
    v_exp_f32 v75, v43
    v_mfma_f32_32x32x16_bf16 v[48:63], v[112:115], v[196:199], v[48:63]
    v_exp_f32 v76, v44
    v_exp_f32 v77, v45
    v_exp_f32 v78, v46
    v_exp_f32 v79, v47
    v_pk_fma_f32 v[80:81], v[80:81], v[64:65], v[80:81]
    s_add_u32 s54, s54, 32
    v_pk_fma_f32 v[120:121], v[88:89], v[64:65], v[88:89]
    s_sub_i32 s44, s35, s54
    v_pk_fma_f32 v[80:81], v[32:33], v[88:89], v[80:81]
    s_lshr_b32 s45, s44, 2
    v_pk_fma_f32 v[80:81], v[80:81], v[66:67], v[80:81]
    s_cmp_lt_i32 s44, 32
    v_pk_fma_f32 v[88:89], v[120:121], v[66:67], v[120:121]
    s_cselect_b32 s28, s45, 8
    v_pk_fma_f32 v[80:81], v[34:35], v[120:121], v[80:81]
    s_addc_u32 s55, s55, 0
    v_pk_fma_f32 v[80:81], v[80:81], v[68:69], v[80:81]
    s_lshl_b32 s30, s55, 9
    v_pk_fma_f32 v[120:121], v[88:89], v[68:69], v[88:89]
    v_readlane_b32 s35, v237, s55
    v_pk_fma_f32 v[80:81], v[36:37], v[88:89], v[80:81]
    v_pk_fma_f32 v[80:81], v[80:81], v[70:71], v[80:81]
    v_pk_fma_f32 v[88:89], v[120:121], v[70:71], v[120:121]
    v_pk_fma_f32 v[80:81], v[38:39], v[120:121], v[80:81]
    v_pk_fma_f32 v[80:81], v[80:81], v[72:73], v[80:81]
    v_pk_fma_f32 v[120:121], v[88:89], v[72:73], v[88:89]
    v_pk_fma_f32 v[80:81], v[40:41], v[88:89], v[80:81]
    v_rcp_f32 v122, v120
    v_rcp_f32 v123, v121
    v_max3_f32 v235, v235, v120, v121
    v_pk_add_f32 v[88:89], v[74:75], v[228:229]
    v_pk_mul_f32 v[124:125], v[80:81], v[122:123]
    v_add_f32 v127, v124, v125
    v_cvt_f64_f32 v[124:125], v127
    ds_add_f64 v233, v[124:125] offset:0
    v_pk_fma_f32 v[80:81], v[42:43], v[76:77], v[42:43]
    v_pk_fma_f32 v[120:121], v[88:89], v[76:77], v[88:89]
    v_pk_fma_f32 v[80:81], v[44:45], v[88:89], v[80:81]
    v_pk_fma_f32 v[80:81], v[80:81], v[78:79], v[80:81]
    v_pk_fma_f32 v[88:89], v[120:121], v[78:79], v[120:121]
    v_pk_fma_f32 v[80:81], v[46:47], v[120:121], v[80:81]
    v_mfma_f32_32x32x16_bf16 v[32:47], v[96:99], v[160:163], 0
    v_exp_f32 v64, v48
    v_exp_f32 v65, v49
    v_exp_f32 v66, v50
    v_mfma_f32_32x32x16_bf16 v[32:47], v[100:103], v[164:167], v[32:47]
    v_exp_f32 v67, v51
    v_exp_f32 v68, v52
    v_exp_f32 v69, v53
    v_mfma_f32_32x32x16_bf16 v[32:47], v[104:107], v[168:171], v[32:47]
    v_exp_f32 v70, v54
    v_exp_f32 v71, v55
    v_exp_f32 v72, v56
    v_mfma_f32_32x32x16_bf16 v[32:47], v[108:111], v[172:175], v[32:47]
    v_exp_f32 v73, v57
    v_exp_f32 v74, v58
    v_exp_f32 v75, v59
    v_mfma_f32_32x32x16_bf16 v[32:47], v[112:115], v[200:203], v[32:47]
    v_exp_f32 v76, v60
    v_exp_f32 v77, v61
    v_exp_f32 v78, v62
    v_exp_f32 v79, v63
    v_pk_fma_f32 v[82:83], v[82:83], v[64:65], v[82:83]
    v_pk_fma_f32 v[120:121], v[90:91], v[64:65], v[90:91]
    v_pk_fma_f32 v[82:83], v[48:49], v[90:91], v[82:83]
    v_pk_fma_f32 v[82:83], v[82:83], v[66:67], v[82:83]
    v_pk_fma_f32 v[90:91], v[120:121], v[66:67], v[120:121]
    v_pk_fma_f32 v[82:83], v[50:51], v[120:121], v[82:83]
    v_pk_fma_f32 v[82:83], v[82:83], v[68:69], v[82:83]
    v_pk_fma_f32 v[120:121], v[90:91], v[68:69], v[90:91]
    v_pk_fma_f32 v[82:83], v[52:53], v[90:91], v[82:83]
    v_pk_fma_f32 v[82:83], v[82:83], v[70:71], v[82:83]
    v_pk_fma_f32 v[90:91], v[120:121], v[70:71], v[120:121]
    v_pk_fma_f32 v[82:83], v[54:55], v[120:121], v[82:83]
    v_pk_fma_f32 v[82:83], v[82:83], v[72:73], v[82:83]
    v_pk_fma_f32 v[120:121], v[90:91], v[72:73], v[90:91]
    v_pk_fma_f32 v[82:83], v[56:57], v[90:91], v[82:83]
    v_rcp_f32 v122, v120
    v_rcp_f32 v123, v121
    v_max3_f32 v235, v235, v120, v121
    v_pk_add_f32 v[90:91], v[74:75], v[228:229]
    v_pk_mul_f32 v[124:125], v[82:83], v[122:123]
    v_add_f32 v127, v124, v125
    v_cvt_f64_f32 v[124:125], v127
    ds_add_f64 v233, v[124:125] offset:256
    v_pk_fma_f32 v[82:83], v[58:59], v[76:77], v[58:59]
    v_pk_fma_f32 v[120:121], v[90:91], v[76:77], v[90:91]
    v_pk_fma_f32 v[82:83], v[60:61], v[90:91], v[82:83]
    v_pk_fma_f32 v[82:83], v[82:83], v[78:79], v[82:83]
    v_pk_fma_f32 v[90:91], v[120:121], v[78:79], v[120:121]
    v_pk_fma_f32 v[82:83], v[62:63], v[120:121], v[82:83]
    v_mfma_f32_32x32x16_bf16 v[48:63], v[96:99], v[176:179], 0
    v_exp_f32 v64, v32
    v_exp_f32 v65, v33
    v_exp_f32 v66, v34
    v_mfma_f32_32x32x16_bf16 v[48:63], v[100:103], v[180:183], v[48:63]
    v_exp_f32 v67, v35
    v_exp_f32 v68, v36
    v_exp_f32 v69, v37
    v_mfma_f32_32x32x16_bf16 v[48:63], v[104:107], v[184:187], v[48:63]
    v_exp_f32 v70, v38
    v_exp_f32 v71, v39
    v_exp_f32 v72, v40
    v_mfma_f32_32x32x16_bf16 v[48:63], v[108:111], v[188:191], v[48:63]
    v_exp_f32 v73, v41
    v_exp_f32 v74, v42
    v_exp_f32 v75, v43
    v_mfma_f32_32x32x16_bf16 v[48:63], v[112:115], v[204:207], v[48:63]
    v_exp_f32 v76, v44
    v_exp_f32 v77, v45
    v_exp_f32 v78, v46
    v_exp_f32 v79, v47
    s_waitcnt vmcnt(0)
    ds_read_b128 v[96:99], v216
    ds_read_b128 v[100:103], v217
    ds_read_b128 v[104:107], v218
    ds_read_b128 v[108:111], v219
    v_pk_mov_b32 v[112:113], v[116:117], v[116:117] op_sel:[0,1]
    v_pk_mov_b32 v[114:115], v[118:119], v[118:119] op_sel:[0,1]
    ds_read_b128 v[116:119], v225
    ds_read_b32 v208, v224 offset:0
    ds_read_b32 v210, v224 offset:128
    ds_read_b32 v212, v224 offset:256
    ds_read_b32 v214, v224 offset:384
    ds_read_b32 v232, v230
    s_cmp_eq_u32 s28, 8
    s_cbranch_scc1 K2_NQv5
    v_add_u32 v226, s30, v222
    s_bitcmp1_b32 s30, 9
    s_cbranch_scc1 K2_OQv5
    ds_read_b32 v194, v226 offset:0
    ds_read_b32 v198, v226 offset:128
    ds_read_b32 v202, v226 offset:256
    ds_read_b32 v206, v226 offset:384
    s_branch K2_NQv5
K2_OQv5:
    ds_read_b32 v195, v226 offset:0
    ds_read_b32 v199, v226 offset:128
    ds_read_b32 v203, v226 offset:256
    ds_read_b32 v207, v226 offset:384
K2_NQv5:
    v_lshl_add_u64 v[224:225], v[224:225], 0, s[56:57]
    v_pk_fma_f32 v[84:85], v[84:85], v[64:65], v[84:85]
    v_pk_fma_f32 v[120:121], v[92:93], v[64:65], v[92:93]
    v_pk_fma_f32 v[84:85], v[32:33], v[92:93], v[84:85]
    v_pk_fma_f32 v[84:85], v[84:85], v[66:67], v[84:85]
    v_pk_fma_f32 v[92:93], v[120:121], v[66:67], v[120:121]
    v_pk_fma_f32 v[84:85], v[34:35], v[120:121], v[84:85]
    v_pk_fma_f32 v[84:85], v[84:85], v[68:69], v[84:85]
    v_pk_fma_f32 v[120:121], v[92:93], v[68:69], v[92:93]
    v_pk_fma_f32 v[84:85], v[36:37], v[92:93], v[84:85]
    v_pk_fma_f32 v[84:85], v[84:85], v[70:71], v[84:85]
    v_pk_fma_f32 v[92:93], v[120:121], v[70:71], v[120:121]
    v_pk_fma_f32 v[84:85], v[38:39], v[120:121], v[84:85]
    v_pk_fma_f32 v[84:85], v[84:85], v[72:73], v[84:85]
    v_pk_fma_f32 v[120:121], v[92:93], v[72:73], v[92:93]
    v_pk_fma_f32 v[84:85], v[40:41], v[92:93], v[84:85]
    v_rcp_f32 v122, v120
    v_rcp_f32 v123, v121
    v_max3_f32 v235, v235, v120, v121
    v_pk_add_f32 v[92:93], v[74:75], v[228:229]
    v_pk_mul_f32 v[124:125], v[84:85], v[122:123]
    v_add_f32 v127, v124, v125
    v_cvt_f64_f32 v[124:125], v127
    ds_add_f64 v233, v[124:125] offset:512
    v_pk_fma_f32 v[84:85], v[42:43], v[76:77], v[42:43]
    v_pk_fma_f32 v[120:121], v[92:93], v[76:77], v[92:93]
    v_pk_fma_f32 v[84:85], v[44:45], v[92:93], v[84:85]
    v_pk_fma_f32 v[84:85], v[84:85], v[78:79], v[84:85]
    v_pk_fma_f32 v[92:93], v[120:121], v[78:79], v[120:121]
    v_pk_fma_f32 v[84:85], v[46:47], v[120:121], v[84:85]
    s_waitcnt lgkmcnt(0)
    v_add_u32 v236, 1, v236
    buffer_load_dwordx4 v[208:209], s[4:7], 0 idxen offen offset:0 lds
    buffer_load_dwordx4 v[210:211], s[4:7], 0 idxen offen offset:1024 lds
    ds_write_b32 v231, v236
    v_cmp_gt_u32 vcc, v236, v232
    buffer_load_dwordx4 v[212:213], s[4:7], 0 idxen offen offset:2048 lds
    buffer_load_dwordx4 v[214:215], s[4:7], 0 idxen offen offset:3072 lds
    buffer_load_dwordx2 v[116:117], v117, s[8:11], 0 offen
    s_setprio 0
    s_cbranch_vccnz K2_PDv5
    s_setprio 1
K2_PDv5:
    v_mfma_f32_32x32x16_bf16 v[32:47], v[96:99], v[128:131], 0
    v_exp_f32 v64, v48
    v_exp_f32 v65, v49
    v_exp_f32 v66, v50
    v_mfma_f32_32x32x16_bf16 v[32:47], v[100:103], v[132:135], v[32:47]
    v_exp_f32 v67, v51
    v_exp_f32 v68, v52
    v_exp_f32 v69, v53
    v_mfma_f32_32x32x16_bf16 v[32:47], v[104:107], v[136:139], v[32:47]
    v_exp_f32 v70, v54
    v_exp_f32 v71, v55
    v_exp_f32 v72, v56
    v_mfma_f32_32x32x16_bf16 v[32:47], v[108:111], v[140:143], v[32:47]
    v_exp_f32 v73, v57
    v_exp_f32 v74, v58
    v_exp_f32 v75, v59
    v_mfma_f32_32x32x16_bf16 v[32:47], v[112:115], v[192:195], v[32:47]
    v_exp_f32 v76, v60
    v_exp_f32 v77, v61
    v_exp_f32 v78, v62
    v_exp_f32 v79, v63
    v_pk_fma_f32 v[86:87], v[86:87], v[64:65], v[86:87]
    v_pk_fma_f32 v[120:121], v[94:95], v[64:65], v[94:95]
    v_pk_fma_f32 v[86:87], v[48:49], v[94:95], v[86:87]
    v_pk_fma_f32 v[86:87], v[86:87], v[66:67], v[86:87]
    v_pk_fma_f32 v[94:95], v[120:121], v[66:67], v[120:121]
    v_pk_fma_f32 v[86:87], v[50:51], v[120:121], v[86:87]
    v_pk_fma_f32 v[86:87], v[86:87], v[68:69], v[86:87]
    v_pk_fma_f32 v[120:121], v[94:95], v[68:69], v[94:95]
    v_pk_fma_f32 v[86:87], v[52:53], v[94:95], v[86:87]
    v_pk_fma_f32 v[86:87], v[86:87], v[70:71], v[86:87]
    v_pk_fma_f32 v[94:95], v[120:121], v[70:71], v[120:121]
    v_pk_fma_f32 v[86:87], v[54:55], v[120:121], v[86:87]
    v_pk_fma_f32 v[86:87], v[86:87], v[72:73], v[86:87]
    v_pk_fma_f32 v[120:121], v[94:95], v[72:73], v[94:95]
    v_pk_fma_f32 v[86:87], v[56:57], v[94:95], v[86:87]
    v_rcp_f32 v122, v120
    v_rcp_f32 v123, v121
    v_max3_f32 v235, v235, v120, v121
    v_pk_add_f32 v[94:95], v[74:75], v[228:229]
    v_pk_mul_f32 v[124:125], v[86:87], v[122:123]
    v_add_f32 v127, v124, v125
    v_cvt_f64_f32 v[124:125], v127
    ds_add_f64 v233, v[124:125] offset:768
    v_pk_fma_f32 v[86:87], v[58:59], v[76:77], v[58:59]
    v_pk_fma_f32 v[120:121], v[94:95], v[76:77], v[94:95]
    v_pk_fma_f32 v[86:87], v[60:61], v[94:95], v[86:87]
    v_pk_fma_f32 v[86:87], v[86:87], v[78:79], v[86:87]
    v_pk_fma_f32 v[94:95], v[120:121], v[78:79], v[120:121]
    v_pk_fma_f32 v[86:87], v[62:63], v[120:121], v[86:87]
    s_cmp_ge_u32 s54, s24
    s_cbranch_scc1 K2_FLUSH
    s_cmp_eq_u32 s28, 8
    s_cbranch_scc1 K2_V8
    s_branch K2_DO
K2_DL:
    s_cmp_lt_u32 s28, 2
    s_cbranch_scc1 K2_D01
    s_cmp_eq_u32 s28, 2
    s_cbranch_scc1 K2_V2
    .p2align 6
K2_V3:
    v_lshl_add_u32 v233, s27, 1, v223
    s_mov_b32 s27, s30
    v_mfma_f32_32x32x16_bf16 v[48:63], v[96:99], v[144:147], 0
    v_exp_f32 v64, v32
    v_exp_f32 v65, v33
    v_exp_f32 v66, v34
    v_mfma_f32_32x32x16_bf16 v[48:63], v[100:103], v[148:151], v[48:63]
    v_exp_f32 v67, v35
    v_exp_f32 v68, v36
    v_exp_f32 v69, v37
    v_mfma_f32_32x32x16_bf16 v[48:63], v[104:107], v[152:155], v[48:63]
    v_exp_f32 v70, v38
    v_exp_f32 v71, v39
    v_exp_f32 v72, v40
    v_mfma_f32_32x32x16_bf16 v[48:63], v[108:111], v[156:159], v[48:63]
    v_exp_f32 v73, v41
    v_exp_f32 v74, v42
    v_exp_f32 v75, v43
    v_mfma_f32_32x32x16_bf16 v[48:63], v[112:115], v[196:199], v[48:63]
    v_exp_f32 v76, v44
    v_exp_f32 v77, v45
    v_exp_f32 v78, v46
    v_exp_f32 v79, v47
    v_pk_fma_f32 v[80:81], v[80:81], v[64:65], v[80:81]
    s_add_u32 s54, s54, 32
    v_pk_fma_f32 v[120:121], v[88:89], v[64:65], v[88:89]
    s_sub_i32 s44, s35, s54
    v_pk_fma_f32 v[80:81], v[32:33], v[88:89], v[80:81]
    s_lshr_b32 s45, s44, 2
    v_pk_fma_f32 v[80:81], v[80:81], v[66:67], v[80:81]
    s_cmp_lt_i32 s44, 32
    v_pk_fma_f32 v[88:89], v[120:121], v[66:67], v[120:121]
    s_cselect_b32 s28, s45, 8
    v_pk_fma_f32 v[80:81], v[34:35], v[120:121], v[80:81]
    s_addc_u32 s55, s55, 0
    v_pk_fma_f32 v[80:81], v[80:81], v[68:69], v[80:81]
    s_lshl_b32 s30, s55, 9
    v_pk_fma_f32 v[120:121], v[88:89], v[68:69], v[88:89]
    v_readlane_b32 s35, v237, s55
    v_pk_fma_f32 v[80:81], v[36:37], v[88:89], v[80:81]
    v_rcp_f32 v122, v120
    v_rcp_f32 v123, v121
    v_max3_f32 v235, v235, v120, v121
    v_pk_add_f32 v[88:89], v[70:71], v[228:229]
    v_pk_mul_f32 v[124:125], v[80:81], v[122:123]
    v_add_f32 v127, v124, v125
    v_cvt_f64_f32 v[124:125], v127
    ds_add_f64 v233, v[124:125] offset:0
    v_pk_fma_f32 v[80:81], v[38:39], v[72:73], v[38:39]
    v_pk_fma_f32 v[120:121], v[88:89], v[72:73], v[88:89]
    v_pk_fma_f32 v[80:81], v[40:41], v[88:89], v[80:81]
    v_pk_fma_f32 v[80:81], v[80:81], v[74:75], v[80:81]
    v_pk_fma_f32 v[88:89], v[120:121], v[74:75], v[120:121]
    v_pk_fma_f32 v[80:81], v[42:43], v[120:121], v[80:81]
    v_pk_fma_f32 v[80:81], v[80:81], v[76:77], v[80:81]
    v_pk_fma_f32 v[120:121], v[88:89], v[76:77], v[88:89]
    v_pk_fma_f32 v[80:81], v[44:45], v[88:89], v[80:81]
    v_pk_fma_f32 v[80:81], v[80:81], v[78:79], v[80:81]
    v_pk_fma_f32 v[88:89], v[120:121], v[78:79], v[120:121]
    v_pk_fma_f32 v[80:81], v[46:47], v[120:121], v[80:81]
    v_mfma_f32_32x32x16_bf16 v[32:47], v[96:99], v[160:163], 0
    v_exp_f32 v64, v48
    v_exp_f32 v65, v49
    v_exp_f32 v66, v50
    v_mfma_f32_32x32x16_bf16 v[32:47], v[100:103], v[164:167], v[32:47]
    v_exp_f32 v67, v51
    v_exp_f32 v68, v52
    v_exp_f32 v69, v53
    v_mfma_f32_32x32x16_bf16 v[32:47], v[104:107], v[168:171], v[32:47]
    v_exp_f32 v70, v54
    v_exp_f32 v71, v55
    v_exp_f32 v72, v56
    v_mfma_f32_32x32x16_bf16 v[32:47], v[108:111], v[172:175], v[32:47]
    v_exp_f32 v73, v57
    v_exp_f32 v74, v58
    v_exp_f32 v75, v59
    v_mfma_f32_32x32x16_bf16 v[32:47], v[112:115], v[200:203], v[32:47]
    v_exp_f32 v76, v60
    v_exp_f32 v77, v61
    v_exp_f32 v78, v62
    v_exp_f32 v79, v63
    v_pk_fma_f32 v[82:83], v[82:83], v[64:65], v[82:83]
    v_pk_fma_f32 v[120:121], v[90:91], v[64:65], v[90:91]
    v_pk_fma_f32 v[82:83], v[48:49], v[90:91], v[82:83]
    v_pk_fma_f32 v[82:83], v[82:83], v[66:67], v[82:83]
    v_pk_fma_f32 v[90:91], v[120:121], v[66:67], v[120:121]
    v_pk_fma_f32 v[82:83], v[50:51], v[120:121], v[82:83]
    v_pk_fma_f32 v[82:83], v[82:83], v[68:69], v[82:83]
    v_pk_fma_f32 v[120:121], v[90:91], v[68:69], v[90:91]
    v_pk_fma_f32 v[82:83], v[52:53], v[90:91], v[82:83]
    v_rcp_f32 v122, v120
    v_rcp_f32 v123, v121
    v_max3_f32 v235, v235, v120, v121
    v_pk_add_f32 v[90:91], v[70:71], v[228:229]
    v_pk_mul_f32 v[124:125], v[82:83], v[122:123]
    v_add_f32 v127, v124, v125
    v_cvt_f64_f32 v[124:125], v127
    ds_add_f64 v233, v[124:125] offset:256
    v_pk_fma_f32 v[82:83], v[54:55], v[72:73], v[54:55]
    v_pk_fma_f32 v[120:121], v[90:91], v[72:73], v[90:91]
    v_pk_fma_f32 v[82:83], v[56:57], v[90:91], v[82:83]
    v_pk_fma_f32 v[82:83], v[82:83], v[74:75], v[82:83]
    v_pk_fma_f32 v[90:91], v[120:121], v[74:75], v[120:121]
    v_pk_fma_f32 v[82:83], v[58:59], v[120:121], v[82:83]
    v_pk_fma_f32 v[82:83], v[82:83], v[76:77], v[82:83]
    v_pk_fma_f32 v[120:121], v[90:91], v[76:77], v[90:91]
    v_pk_fma_f32 v[82:83], v[60:61], v[90:91], v[82:83]
    v_pk_fma_f32 v[82:83], v[82:83], v[78:79], v[82:83]
    v_pk_fma_f32 v[90:91], v[120:121], v[78:79], v[120:121]
    v_pk_fma_f32 v[82:83], v[62:63], v[120:121], v[82:83]
    v_mfma_f32_32x32x16_bf16 v[48:63], v[96:99], v[176:179], 0
    v_exp_f32 v64, v32
    v_exp_f32 v65, v33
    v_exp_f32 v66, v34
    v_mfma_f32_32x32x16_bf16 v[48:63], v[100:103], v[180:183], v[48:63]
    v_exp_f32 v67, v35
    v_exp_f32 v68, v36
    v_exp_f32 v69, v37
    v_mfma_f32_32x32x16_bf16 v[48:63], v[104:107], v[184:187], v[48:63]
    v_exp_f32 v70, v38
    v_exp_f32 v71, v39
    v_exp_f32 v72, v40
    v_mfma_f32_32x32x16_bf16 v[48:63], v[108:111], v[188:191], v[48:63]
    v_exp_f32 v73, v41
    v_exp_f32 v74, v42
    v_exp_f32 v75, v43
    v_mfma_f32_32x32x16_bf16 v[48:63], v[112:115], v[204:207], v[48:63]
    v_exp_f32 v76, v44
    v_exp_f32 v77, v45
    v_exp_f32 v78, v46
    v_exp_f32 v79, v47
    s_waitcnt vmcnt(0)
    ds_read_b128 v[96:99], v216
    ds_read_b128 v[100:103], v217
    ds_read_b128 v[104:107], v218
    ds_read_b128 v[108:111], v219
    v_pk_mov_b32 v[112:113], v[116:117], v[116:117] op_sel:[0,1]
    v_pk_mov_b32 v[114:115], v[118:119], v[118:119] op_sel:[0,1]
    ds_read_b128 v[116:119], v225
    ds_read_b32 v208, v224 offset:0
    ds_read_b32 v210, v224 offset:128
    ds_read_b32 v212, v224 offset:256
    ds_read_b32 v214, v224 offset:384
    ds_read_b32 v232, v230
    s_cmp_eq_u32 s28, 8
    s_cbranch_scc1 K2_NQv3
    v_add_u32 v226, s30, v222
    s_bitcmp1_b32 s30, 9
    s_cbranch_scc1 K2_OQv3
    ds_read_b32 v194, v226 offset:0
    ds_read_b32 v198, v226 offset:128
    ds_read_b32 v202, v226 offset:256
    ds_read_b32 v206, v226 offset:384
    s_branch K2_NQv3
K2_OQv3:
    ds_read_b32 v195, v226 offset:0
    ds_read_b32 v199, v226 offset:128
    ds_read_b32 v203, v226 offset:256
    ds_read_b32 v207, v226 offset:384
K2_NQv3:
    v_lshl_add_u64 v[224:225], v[224:225], 0, s[56:57]
    v_pk_fma_f32 v[84:85], v[84:85], v[64:65], v[84:85]
    v_pk_fma_f32 v[120:121], v[92:93], v[64:65], v[92:93]
    v_pk_fma_f32 v[84:85], v[32:33], v[92:93], v[84:85]
    v_pk_fma_f32 v[84:85], v[84:85], v[66:67], v[84:85]
    v_pk_fma_f32 v[92:93], v[120:121], v[66:67], v[120:121]
    v_pk_fma_f32 v[84:85], v[34:35], v[120:121], v[84:85]
    v_pk_fma_f32 v[84:85], v[84:85], v[68:69], v[84:85]
    v_pk_fma_f32 v[120:121], v[92:93], v[68:69], v[92:93]
    v_pk_fma_f32 v[84:85], v[36:37], v[92:93], v[84:85]
    v_rcp_f32 v122, v120
    v_rcp_f32 v123, v121
    v_max3_f32 v235, v235, v120, v121
    v_pk_add_f32 v[92:93], v[70:71], v[228:229]
    v_pk_mul_f32 v[124:125], v[84:85], v[122:123]
    v_add_f32 v127, v124, v125
    v_cvt_f64_f32 v[124:125], v127
    ds_add_f64 v233, v[124:125] offset:512
    v_pk_fma_f32 v[84:85], v[38:39], v[72:73], v[38:39]
    v_pk_fma_f32 v[120:121], v[92:93], v[72:73], v[92:93]
    v_pk_fma_f32 v[84:85], v[40:41], v[92:93], v[84:85]
    v_pk_fma_f32 v[84:85], v[84:85], v[74:75], v[84:85]
    v_pk_fma_f32 v[92:93], v[120:121], v[74:75], v[120:121]
    v_pk_fma_f32 v[84:85], v[42:43], v[120:121], v[84:85]
    v_pk_fma_f32 v[84:85], v[84:85], v[76:77], v[84:85]
    v_pk_fma_f32 v[120:121], v[92:93], v[76:77], v[92:93]
    v_pk_fma_f32 v[84:85], v[44:45], v[92:93], v[84:85]
    v_pk_fma_f32 v[84:85], v[84:85], v[78:79], v[84:85]
    v_pk_fma_f32 v[92:93], v[120:121], v[78:79], v[120:121]
    v_pk_fma_f32 v[84:85], v[46:47], v[120:121], v[84:85]
    s_waitcnt lgkmcnt(0)
    v_add_u32 v236, 1, v236
    buffer_load_dwordx4 v[208:209], s[4:7], 0 idxen offen offset:0 lds
    buffer_load_dwordx4 v[210:211], s[4:7], 0 idxen offen offset:1024 lds
    ds_write_b32 v231, v236
    v_cmp_gt_u32 vcc, v236, v232
    buffer_load_dwordx4 v[212:213], s[4:7], 0 idxen offen offset:2048 lds
    buffer_load_dwordx4 v[214:215], s[4:7], 0 idxen offen offset:3072 lds
    buffer_load_dwordx2 v[116:117], v117, s[8:11], 0 offen
    s_setprio 0
    s_cbranch_vccnz K2_PDv3
    s_setprio 1
K2_PDv3:
    v_mfma_f32_32x32x16_bf16 v[32:47], v[96:99], v[128:131], 0
    v_exp_f32 v64, v48
    v_exp_f32 v65, v49
    v_exp_f32 v66, v50
    v_mfma_f32_32x32x16_bf16 v[32:47], v[100:103], v[132:135], v[32:47]
    v_exp_f32 v67, v51
    v_exp_f32 v68, v52
    v_exp_f32 v69, v53
    v_mfma_f32_32x32x16_bf16 v[32:47], v[104:107], v[136:139], v[32:47]
    v_exp_f32 v70, v54
    v_exp_f32 v71, v55
    v_exp_f32 v72, v56
    v_mfma_f32_32x32x16_bf16 v[32:47], v[108:111], v[140:143], v[32:47]
    v_exp_f32 v73, v57
    v_exp_f32 v74, v58
    v_exp_f32 v75, v59
    v_mfma_f32_32x32x16_bf16 v[32:47], v[112:115], v[192:195], v[32:47]
    v_exp_f32 v76, v60
    v_exp_f32 v77, v61
    v_exp_f32 v78, v62
    v_exp_f32 v79, v63
    v_pk_fma_f32 v[86:87], v[86:87], v[64:65], v[86:87]
    v_pk_fma_f32 v[120:121], v[94:95], v[64:65], v[94:95]
    v_pk_fma_f32 v[86:87], v[48:49], v[94:95], v[86:87]
    v_pk_fma_f32 v[86:87], v[86:87], v[66:67], v[86:87]
    v_pk_fma_f32 v[94:95], v[120:121], v[66:67], v[120:121]
    v_pk_fma_f32 v[86:87], v[50:51], v[120:121], v[86:87]
    v_pk_fma_f32 v[86:87], v[86:87], v[68:69], v[86:87]
    v_pk_fma_f32 v[120:121], v[94:95], v[68:69], v[94:95]
    v_pk_fma_f32 v[86:87], v[52:53], v[94:95], v[86:87]
    v_rcp_f32 v122, v120
    v_rcp_f32 v123, v121
    v_max3_f32 v235, v235, v120, v121
    v_pk_add_f32 v[94:95], v[70:71], v[228:229]
    v_pk_mul_f32 v[124:125], v[86:87], v[122:123]
    v_add_f32 v127, v124, v125
    v_cvt_f64_f32 v[124:125], v127
    ds_add_f64 v233, v[124:125] offset:768
    v_pk_fma_f32 v[86:87], v[54:55], v[72:73], v[54:55]
    v_pk_fma_f32 v[120:121], v[94:95], v[72:73], v[94:95]
    v_pk_fma_f32 v[86:87], v[56:57], v[94:95], v[86:87]
    v_pk_fma_f32 v[86:87], v[86:87], v[74:75], v[86:87]
    v_pk_fma_f32 v[94:95], v[120:121], v[74:75], v[120:121]
    v_pk_fma_f32 v[86:87], v[58:59], v[120:121], v[86:87]
    v_pk_fma_f32 v[86:87], v[86:87], v[76:77], v[86:87]
    v_pk_fma_f32 v[120:121], v[94:95], v[76:77], v[94:95]
    v_pk_fma_f32 v[86:87], v[60:61], v[94:95], v[86:87]
    v_pk_fma_f32 v[86:87], v[86:87], v[78:79], v[86:87]
    v_pk_fma_f32 v[94:95], v[120:121], v[78:79], v[120:121]
    v_pk_fma_f32 v[86:87], v[62:63], v[120:121], v[86:87]
    s_cmp_ge_u32 s54, s24
    s_cbranch_scc1 K2_FLUSH
    s_cmp_eq_u32 s28, 8
    s_cbranch_scc1 K2_V8
    s_branch K2_DO
K2_D01:
    s_cmp_eq_u32 s28, 0
    s_cbranch_scc1 K2_V0
    .p2align 6
K2_V1:
    v_lshl_add_u32 v233, s27, 1, v223
    s_mov_b32 s27, s30
    v_mfma_f32_32x32x16_bf16 v[48:63], v[96:99], v[144:147], 0
    v_exp_f32 v64, v32
    v_exp_f32 v65, v33
    v_exp_f32 v66, v34
    v_mfma_f32_32x32x16_bf16 v[48:63], v[100:103], v[148:151], v[48:63]
    v_exp_f32 v67, v35
    v_exp_f32 v68, v36
    v_exp_f32 v69, v37
    v_mfma_f32_32x32x16_bf16 v[48:63], v[104:107], v[152:155], v[48:63]
    v_exp_f32 v70, v38
    v_exp_f32 v71, v39
    v_exp_f32 v72, v40
    v_mfma_f32_32x32x16_bf16 v[48:63], v[108:111], v[156:159], v[48:63]
    v_exp_f32 v73, v41
    v_exp_f32 v74, v42
    v_exp_f32 v75, v43
    v_mfma_f32_32x32x16_bf16 v[48:63], v[112:115], v[196:199], v[48:63]
    v_exp_f32 v76, v44
    v_exp_f32 v77, v45
    v_exp_f32 v78, v46
    v_exp_f32 v79, v47
    v_pk_fma_f32 v[80:81], v[80:81], v[64:65], v[80:81]
    s_add_u32 s54, s54, 32
    v_pk_fma_f32 v[120:121], v[88:89], v[64:65], v[88:89]
    s_sub_i32 s44, s35, s54
    v_pk_fma_f32 v[80:81], v[32:33], v[88:89], v[80:81]
    s_lshr_b32 s45, s44, 2
    v_rcp_f32 v122, v120
    v_rcp_f32 v123, v121
    v_max3_f32 v235, v235, v120, v121
    v_pk_add_f32 v[88:89], v[66:67], v[228:229]
    s_cmp_lt_i32 s44, 32
    v_pk_mul_f32 v[124:125], v[80:81], v[122:123]
    s_cselect_b32 s28, s45, 8
    v_add_f32 v127, v124, v125
    v_cvt_f64_f32 v[124:125], v127
    ds_add_f64 v233, v[124:125] offset:0
    v_pk_fma_f32 v[80:81], v[34:35], v[68:69], v[34:35]
    s_addc_u32 s55, s55, 0
    v_pk_fma_f32 v[120:121], v[88:89], v[68:69], v[88:89]
    s_lshl_b32 s30, s55, 9
    v_pk_fma_f32 v[80:81], v[36:37], v[88:89], v[80:81]
    v_readlane_b32 s35, v237, s55
    v_pk_fma_f32 v[80:81], v[80:81], v[70:71], v[80:81]
    v_pk_fma_f32 v[88:89], v[120:121], v[70:71], v[120:121]
    v_pk_fma_f32 v[80:81], v[38:39], v[120:121], v[80:81]
    v_pk_fma_f32 v[80:81], v[80:81], v[72:73], v[80:81]
    v_pk_fma_f32 v[120:121], v[88:89], v[72:73], v[88:89]
    v_pk_fma_f32 v[80:81], v[40:41], v[88:89], v[80:81]
    v_pk_fma_f32 v[80:81], v[80:81], v[74:75], v[80:81]
    v_pk_fma_f32 v[88:89], v[120:121], v[74:75], v[120:121]
    v_pk_fma_f32 v[80:81], v[42:43], v[120:121], v[80:81]
    v_pk_fma_f32 v[80:81], v[80:81], v[76:77], v[80:81]
    v_pk_fma_f32 v[120:121], v[88:89], v[76:77], v[88:89]
    v_pk_fma_f32 v[80:81], v[44:45], v[88:89], v[80:81]
    v_pk_fma_f32 v[80:81], v[80:81], v[78:79], v[80:81]
    v_pk_fma_f32 v[88:89], v[120:121], v[78:79], v[120:121]
    v_pk_fma_f32 v[80:81], v[46:47], v[120:121], v[80:81]
    v_mfma_f32_32x32x16_bf16 v[32:47], v[96:99], v[160:163], 0
    v_exp_f32 v64, v48
    v_exp_f32 v65, v49
    v_exp_f32 v66, v50
    v_mfma_f32_32x32x16_bf16 v[32:47], v[100:103], v[164:167], v[32:47]
    v_exp_f32 v67, v51
    v_exp_f32 v68, v52
    v_exp_f32 v69, v53
    v_mfma_f32_32x32x16_bf16 v[32:47], v[104:107], v[168:171], v[32:47]
    v_exp_f32 v70, v54
    v_exp_f32 v71, v55
    v_exp_f32 v72, v56
    v_mfma_f32_32x32x16_bf16 v[32:47], v[108:111], v[172:175], v[32:47]
    v_exp_f32 v73, v57
    v_exp_f32 v74, v58
    v_exp_f32 v75, v59
    v_mfma_f32_32x32x16_bf16 v[32:47], v[112:115], v[200:203], v[32:47]
    v_exp_f32 v76, v60
    v_exp_f32 v77, v61
    v_exp_f32 v78, v62
    v_exp_f32 v79, v63
    v_pk_fma_f32 v[82:83], v[82:83], v[64:65], v[82:83]
    v_pk_fma_f32 v[120:121], v[90:91], v[64:65], v[90:91]
    v_pk_fma_f32 v[82:83], v[48:49], v[90:91], v[82:83]
    v_rcp_f32 v122, v120
    v_rcp_f32 v123, v121
    v_max3_f32 v235, v235, v120, v121
    v_pk_add_f32 v[90:91], v[66:67], v[228:229]
    v_pk_mul_f32 v[124:125], v[82:83], v[122:123]
    v_add_f32 v127, v124, v125
    v_cvt_f64_f32 v[124:125], v127
    ds_add_f64 v233, v[124:125] offset:256
    v_pk_fma_f32 v[82:83], v[50:51], v[68:69], v[50:51]
    v_pk_fma_f32 v[120:121], v[90:91], v[68:69], v[90:91]
    v_pk_fma_f32 v[82:83], v[52:53], v[90:91], v[82:83]
    v_pk_fma_f32 v[82:83], v[82:83], v[70:71], v[82:83]
    v_pk_fma_f32 v[90:91], v[120:121], v[70:71], v[120:121]
    v_pk_fma_f32 v[82:83], v[54:55], v[120:121], v[82:83]
    v_pk_fma_f32 v[82:83], v[82:83], v[72:73], v[82:83]
    v_pk_fma_f32 v[120:121], v[90:91], v[72:73], v[90:91]
    v_pk_fma_f32 v[82:83], v[56:57], v[90:91], v[82:83]
    v_pk_fma_f32 v[82:83], v[82:83], v[74:75], v[82:83]
    v_pk_fma_f32 v[90:91], v[120:121], v[74:75], v[120:121]
    v_pk_fma_f32 v[82:83], v[58:59], v[120:121], v[82:83]
    v_pk_fma_f32 v[82:83], v[82:83], v[76:77], v[82:83]
    v_pk_fma_f32 v[120:121], v[90:91], v[76:77], v[90:91]
    v_pk_fma_f32 v[82:83], v[60:61], v[90:91], v[82:83]
    v_pk_fma_f32 v[82:83], v[82:83], v[78:79], v[82:83]
    v_pk_fma_f32 v[90:91], v[120:121], v[78:79], v[120:121]
    v_pk_fma_f32 v[82:83], v[62:63], v[120:121], v[82:83]
    v_mfma_f32_32x32x16_bf16 v[48:63], v[96:99], v[176:179], 0
    v_exp_f32 v64, v32
    v_exp_f32 v65, v33
    v_exp_f32 v66, v34
    v_mfma_f32_32x32x16_bf16 v[48:63], v[100:103], v[180:183], v[48:63]
    v_exp_f32 v67, v35
    v_exp_f32 v68, v36
    v_exp_f32 v69, v37
    v_mfma_f32_32x32x16_bf16 v[48:63], v[104:107], v[184:187], v[48:63]
    v_exp_f32 v70, v38
    v_exp_f32 v71, v39
    v_exp_f32 v72, v40
    v_mfma_f32_32x32x16_bf16 v[48:63], v[108:111], v[188:191], v[48:63]
    v_exp_f32 v73, v41
    v_exp_f32 v74, v42
    v_exp_f32 v75, v43
    v_mfma_f32_32x32x16_bf16 v[48:63], v[112:115], v[204:207], v[48:63]
    v_exp_f32 v76, v44
    v_exp_f32 v77, v45
    v_exp_f32 v78, v46
    v_exp_f32 v79, v47
    s_waitcnt vmcnt(0)
    ds_read_b128 v[96:99], v216
    ds_read_b128 v[100:103], v217
    ds_read_b128 v[104:107], v218
    ds_read_b128 v[108:111], v219
    v_pk_mov_b32 v[112:113], v[116:117], v[116:117] op_sel:[0,1]
    v_pk_mov_b32 v[114:115], v[118:119], v[118:119] op_sel:[0,1]
    ds_read_b128 v[116:119], v225
    ds_read_b32 v208, v224 offset:0
    ds_read_b32 v210, v224 offset:128
    ds_read_b32 v212, v224 offset:256
    ds_read_b32 v214, v224 offset:384
    ds_read_b32 v232, v230
    s_cmp_eq_u32 s28, 8
    s_cbranch_scc1 K2_NQv1
    v_add_u32 v226, s30, v222
    s_bitcmp1_b32 s30, 9
    s_cbranch_scc1 K2_OQv1
    ds_read_b32 v194, v226 offset:0
    ds_read_b32 v198, v226 offset:128
    ds_read_b32 v202, v226 offset:256
    ds_read_b32 v206, v226 offset:384
    s_branch K2_NQv1
K2_OQv1:
    ds_read_b32 v195, v226 offset:0
    ds_read_b32 v199, v226 offset:128
    ds_read_b32 v203, v226 offset:256
    ds_read_b32 v207, v226 offset:384
K2_NQv1:
    v_lshl_add_u64 v[224:225], v[224:225], 0, s[56:57]
    v_pk_fma_f32 v[84:85], v[84:85], v[64:65], v[84:85]
    v_pk_fma_f32 v[120:121], v[92:93], v[64:65], v[92:93]
    v_pk_fma_f32 v[84:85], v[32:33], v[92:93], v[84:85]
    v_rcp_f32 v122, v120
    v_rcp_f32 v123, v121
    v_max3_f32 v235, v235, v120, v121
    v_pk_add_f32 v[92:93], v[66:67], v[228:229]
    v_pk_mul_f32 v[124:125], v[84:85], v[122:123]
    v_add_f32 v127, v124, v125
    v_cvt_f64_f32 v[124:125], v127
    ds_add_f64 v233, v[124:125] offset:512
    v_pk_fma_f32 v[84:85], v[34:35], v[68:69], v[34:35]
    v_pk_fma_f32 v[120:121], v[92:93], v[68:69], v[92:93]
    v_pk_fma_f32 v[84:85], v[36:37], v[92:93], v[84:85]
    v_pk_fma_f32 v[84:85], v[84:85], v[70:71], v[84:85]
    v_pk_fma_f32 v[92:93], v[120:121], v[70:71], v[120:121]
    v_pk_fma_f32 v[84:85], v[38:39], v[120:121], v[84:85]
    v_pk_fma_f32 v[84:85], v[84:85], v[72:73], v[84:85]
    v_pk_fma_f32 v[120:121], v[92:93], v[72:73], v[92:93]
    v_pk_fma_f32 v[84:85], v[40:41], v[92:93], v[84:85]
    v_pk_fma_f32 v[84:85], v[84:85], v[74:75], v[84:85]
    v_pk_fma_f32 v[92:93], v[120:121], v[74:75], v[120:121]
    v_pk_fma_f32 v[84:85], v[42:43], v[120:121], v[84:85]
    v_pk_fma_f32 v[84:85], v[84:85], v[76:77], v[84:85]
    v_pk_fma_f32 v[120:121], v[92:93], v[76:77], v[92:93]
    v_pk_fma_f32 v[84:85], v[44:45], v[92:93], v[84:85]
    v_pk_fma_f32 v[84:85], v[84:85], v[78:79], v[84:85]
    v_pk_fma_f32 v[92:93], v[120:121], v[78:79], v[120:121]
    v_pk_fma_f32 v[84:85], v[46:47], v[120:121], v[84:85]
    s_waitcnt lgkmcnt(0)
    v_add_u32 v236, 1, v236
    buffer_load_dwordx4 v[208:209], s[4:7], 0 idxen offen offset:0 lds
    buffer_load_dwordx4 v[210:211], s[4:7], 0 idxen offen offset:1024 lds
    ds_write_b32 v231, v236
    v_cmp_gt_u32 vcc, v236, v232
    buffer_load_dwordx4 v[212:213], s[4:7], 0 idxen offen offset:2048 lds
    buffer_load_dwordx4 v[214:215], s[4:7], 0 idxen offen offset:3072 lds
    buffer_load_dwordx2 v[116:117], v117, s[8:11], 0 offen
    s_setprio 0
    s_cbranch_vccnz K2_PDv1
    s_setprio 1
K2_PDv1:
    v_mfma_f32_32x32x16_bf16 v[32:47], v[96:99], v[128:131], 0
    v_exp_f32 v64, v48
    v_exp_f32 v65, v49
    v_exp_f32 v66, v50
    v_mfma_f32_32x32x16_bf16 v[32:47], v[100:103], v[132:135], v[32:47]
    v_exp_f32 v67, v51
    v_exp_f32 v68, v52
    v_exp_f32 v69, v53
    v_mfma_f32_32x32x16_bf16 v[32:47], v[104:107], v[136:139], v[32:47]
    v_exp_f32 v70, v54
    v_exp_f32 v71, v55
    v_exp_f32 v72, v56
    v_mfma_f32_32x32x16_bf16 v[32:47], v[108:111], v[140:143], v[32:47]
    v_exp_f32 v73, v57
    v_exp_f32 v74, v58
    v_exp_f32 v75, v59
    v_mfma_f32_32x32x16_bf16 v[32:47], v[112:115], v[192:195], v[32:47]
    v_exp_f32 v76, v60
    v_exp_f32 v77, v61
    v_exp_f32 v78, v62
    v_exp_f32 v79, v63
    v_pk_fma_f32 v[86:87], v[86:87], v[64:65], v[86:87]
    v_pk_fma_f32 v[120:121], v[94:95], v[64:65], v[94:95]
    v_pk_fma_f32 v[86:87], v[48:49], v[94:95], v[86:87]
    v_rcp_f32 v122, v120
    v_rcp_f32 v123, v121
    v_max3_f32 v235, v235, v120, v121
    v_pk_add_f32 v[94:95], v[66:67], v[228:229]
    v_pk_mul_f32 v[124:125], v[86:87], v[122:123]
    v_add_f32 v127, v124, v125
    v_cvt_f64_f32 v[124:125], v127
    ds_add_f64 v233, v[124:125] offset:768
    v_pk_fma_f32 v[86:87], v[50:51], v[68:69], v[50:51]
    v_pk_fma_f32 v[120:121], v[94:95], v[68:69], v[94:95]
    v_pk_fma_f32 v[86:87], v[52:53], v[94:95], v[86:87]
    v_pk_fma_f32 v[86:87], v[86:87], v[70:71], v[86:87]
    v_pk_fma_f32 v[94:95], v[120:121], v[70:71], v[120:121]
    v_pk_fma_f32 v[86:87], v[54:55], v[120:121], v[86:87]
    v_pk_fma_f32 v[86:87], v[86:87], v[72:73], v[86:87]
    v_pk_fma_f32 v[120:121], v[94:95], v[72:73], v[94:95]
    v_pk_fma_f32 v[86:87], v[56:57], v[94:95], v[86:87]
    v_pk_fma_f32 v[86:87], v[86:87], v[74:75], v[86:87]
    v_pk_fma_f32 v[94:95], v[120:121], v[74:75], v[120:121]
    v_pk_fma_f32 v[86:87], v[58:59], v[120:121], v[86:87]
    v_pk_fma_f32 v[86:87], v[86:87], v[76:77], v[86:87]
    v_pk_fma_f32 v[120:121], v[94:95], v[76:77], v[94:95]
    v_pk_fma_f32 v[86:87], v[60:61], v[94:95], v[86:87]
    v_pk_fma_f32 v[86:87], v[86:87], v[78:79], v[86:87]
    v_pk_fma_f32 v[94:95], v[120:121], v[78:79], v[120:121]
    v_pk_fma_f32 v[86:87], v[62:63], v[120:121], v[86:87]
    s_cmp_ge_u32 s54, s24
    s_cbranch_scc1 K2_FLUSH
    s_cmp_eq_u32 s28, 8
    s_cbranch_scc1 K2_V8
    s_branch K2_DO
    .p2align 6
K2_V0:
    v_lshl_add_u32 v233, s27, 1, v223
    s_mov_b32 s27, s30
    v_mfma_f32_32x32x16_bf16 v[48:63], v[96:99], v[144:147], 0
    v_exp_f32 v64, v32
    v_exp_f32 v65, v33
    v_exp_f32 v66, v34
    v_mfma_f32_32x32x16_bf16 v[48:63], v[100:103], v[148:151], v[48:63]
    v_exp_f32 v67, v35
    v_exp_f32 v68, v36
    v_exp_f32 v69, v37
    v_mfma_f32_32x32x16_bf16 v[48:63], v[104:107], v[152:155], v[48:63]
    v_exp_f32 v70, v38
    v_exp_f32 v71, v39
    v_exp_f32 v72, v40
    v_mfma_f32_32x32x16_bf16 v[48:63], v[108:111], v[156:159], v[48:63]
    v_exp_f32 v73, v41
    v_exp_f32 v74, v42
    v_exp_f32 v75, v43
    v_mfma_f32_32x32x16_bf16 v[48:63], v[112:115], v[196:199], v[48:63]
    v_exp_f32 v76, v44
    v_exp_f32 v77, v45
    v_exp_f32 v78, v46
    v_exp_f32 v79, v47
    v_rcp_f32 v122, v88
    v_rcp_f32 v123, v89
    v_max3_f32 v235, v235, v88, v89
    v_pk_add_f32 v[120:121], v[64:65], v[228:229]
    s_add_u32 s54, s54, 32
    v_pk_mul_f32 v[124:125], v[80:81], v[122:123]
    s_sub_i32 s44, s35, s54
    v_add_f32 v127, v124, v125
    v_cvt_f64_f32 v[124:125], v127
    ds_add_f64 v233, v[124:125] offset:0
    v_pk_fma_f32 v[80:81], v[32:33], v[66:67], v[32:33]
    s_lshr_b32 s45, s44, 2
    v_pk_fma_f32 v[88:89], v[120:121], v[66:67], v[120:121]
    s_cmp_lt_i32 s44, 32
    v_pk_fma_f32 v[80:81], v[34:35], v[120:121], v[80:81]
    s_cselect_b32 s28, s45, 8
    v_pk_fma_f32 v[80:81], v[80:81], v[68:69], v[80:81]
    s_addc_u32 s55, s55, 0
    v_pk_fma_f32 v[120:121], v[88:89], v[68:69], v[88:89]
    s_lshl_b32 s30, s55, 9
    v_pk_fma_f32 v[80:81], v[36:37], v[88:89], v[80:81]
    v_readlane_b32 s35, v237, s55
    v_pk_fma_f32 v[80:81], v[80:81], v[70:71], v[80:81]
    v_pk_fma_f32 v[88:89], v[120:121], v[70:71], v[120:121]
    v_pk_fma_f32 v[80:81], v[38:39], v[120:121], v[80:81]
    v_pk_fma_f32 v[80:81], v[80:81], v[72:73], v[80:81]
    v_pk_fma_f32 v[120:121], v[88:89], v[72:73], v[88:89]
    v_pk_fma_f32 v[80:81], v[40:41], v[88:89], v[80:81]
    v_pk_fma_f32 v[80:81], v[80:81], v[74:75], v[80:81]
    v_pk_fma_f32 v[88:89], v[120:121], v[74:75], v[120:121]
    v_pk_fma_f32 v[80:81], v[42:43], v[120:121], v[80:81]
    v_pk_fma_f32 v[80:81], v[80:81], v[76:77], v[80:81]
    v_pk_fma_f32 v[120:121], v[88:89], v[76:77], v[88:89]
    v_pk_fma_f32 v[80:81], v[44:45], v[88:89], v[80:81]
    v_pk_fma_f32 v[80:81], v[80:81], v[78:79], v[80:81]
    v_pk_fma_f32 v[88:89], v[120:121], v[78:79], v[120:121]
    v_pk_fma_f32 v[80:81], v[46:47], v[120:121], v[80:81]
    v_mfma_f32_32x32x16_bf16 v[32:47], v[96:99], v[160:163], 0
    v_exp_f32 v64, v48
    v_exp_f32 v65, v49
    v_exp_f32 v66, v50
    v_mfma_f32_32x32x16_bf16 v[32:47], v[100:103], v[164:167], v[32:47]
    v_exp_f32 v67, v51
    v_exp_f32 v68, v52
    v_exp_f32 v69, v53
    v_mfma_f32_32x32x16_bf16 v[32:47], v[104:107], v[168:171], v[32:47]
    v_exp_f32 v70, v54
    v_exp_f32 v71, v55
    v_exp_f32 v72, v56
    v_mfma_f32_32x32x16_bf16 v[32:47], v[108:111], v[172:175], v[32:47]
    v_exp_f32 v73, v57
    v_exp_f32 v74, v58
    v_exp_f32 v75, v59
    v_mfma_f32_32x32x16_bf16 v[32:47], v[112:115], v[200:203], v[32:47]
    v_exp_f32 v76, v60
    v_exp_f32 v77, v61
    v_exp_f32 v78, v62
    v_exp_f32 v79, v63
    v_rcp_f32 v122, v90
    v_rcp_f32 v123, v91
    v_max3_f32 v235, v235, v90, v91
    v_pk_add_f32 v[120:121], v[64:65], v[228:229]
    v_pk_mul_f32 v[124:125], v[82:83], v[122:123]
    v_add_f32 v127, v124, v125
    v_cvt_f64_f32 v[124:125], v127
    ds_add_f64 v233, v[124:125] offset:256
    v_pk_fma_f32 v[82:83], v[48:49], v[66:67], v[48:49]
    v_pk_fma_f32 v[90:91], v[120:121], v[66:67], v[120:121]
    v_pk_fma_f32 v[82:83], v[50:51], v[120:121], v[82:83]
    v_pk_fma_f32 v[82:83], v[82:83], v[68:69], v[82:83]
    v_pk_fma_f32 v[120:121], v[90:91], v[68:69], v[90:91]
    v_pk_fma_f32 v[82:83], v[52:53], v[90:91], v[82:83]
    v_pk_fma_f32 v[82:83], v[82:83], v[70:71], v[82:83]
    v_pk_fma_f32 v[90:91], v[120:121], v[70:71], v[120:121]
    v_pk_fma_f32 v[82:83], v[54:55], v[120:121], v[82:83]
    v_pk_fma_f32 v[82:83], v[82:83], v[72:73], v[82:83]
    v_pk_fma_f32 v[120:121], v[90:91], v[72:73], v[90:91]
    v_pk_fma_f32 v[82:83], v[56:57], v[90:91], v[82:83]
    v_pk_fma_f32 v[82:83], v[82:83], v[74:75], v[82:83]
    v_pk_fma_f32 v[90:91], v[120:121], v[74:75], v[120:121]
    v_pk_fma_f32 v[82:83], v[58:59], v[120:121], v[82:83]
    v_pk_fma_f32 v[82:83], v[82:83], v[76:77], v[82:83]
    v_pk_fma_f32 v[120:121], v[90:91], v[76:77], v[90:91]
    v_pk_fma_f32 v[82:83], v[60:61], v[90:91], v[82:83]
    v_pk_fma_f32 v[82:83], v[82:83], v[78:79], v[82:83]
    v_pk_fma_f32 v[90:91], v[120:121], v[78:79], v[120:121]
    v_pk_fma_f32 v[82:83], v[62:63], v[120:121], v[82:83]
    v_mfma_f32_32x32x16_bf16 v[48:63], v[96:99], v[176:179], 0
    v_exp_f32 v64, v32
    v_exp_f32 v65, v33
    v_exp_f32 v66, v34
    v_mfma_f32_32x32x16_bf16 v[48:63], v[100:103], v[180:183], v[48:63]
    v_exp_f32 v67, v35
    v_exp_f32 v68, v36
    v_exp_f32 v69, v37
    v_mfma_f32_32x32x16_bf16 v[48:63], v[104:107], v[184:187], v[48:63]
    v_exp_f32 v70, v38
    v_exp_f32 v71, v39
    v_exp_f32 v72, v40
    v_mfma_f32_32x32x16_bf16 v[48:63], v[108:111], v[188:191], v[48:63]
    v_exp_f32 v73, v41
    v_exp_f32 v74, v42
    v_exp_f32 v75, v43
    v_mfma_f32_32x32x16_bf16 v[48:63], v[112:115], v[204:207], v[48:63]
    v_exp_f32 v76, v44
    v_exp_f32 v77, v45
    v_exp_f32 v78, v46
    v_exp_f32 v79, v47
    s_waitcnt vmcnt(0)
    ds_read_b128 v[96:99], v216
    ds_read_b128 v[100:103], v217
    ds_read_b128 v[104:107], v218
    ds_read_b128 v[108:111], v219
    v_pk_mov_b32 v[112:113], v[116:117], v[116:117] op_sel:[0,1]
    v_pk_mov_b32 v[114:115], v[118:119], v[118:119] op_sel:[0,1]
    ds_read_b128 v[116:119], v225
    ds_read_b32 v208, v224 offset:0
    ds_read_b32 v210, v224 offset:128
    ds_read_b32 v212, v224 offset:256
    ds_read_b32 v214, v224 offset:384
    ds_read_b32 v232, v230
    s_cmp_eq_u32 s28, 8
    s_cbranch_scc1 K2_NQv0
    v_add_u32 v226, s30, v222
    s_bitcmp1_b32 s30, 9
    s_cbranch_scc1 K2_OQv0
    ds_read_b32 v194, v226 offset:0
    ds_read_b32 v198, v226 offset:128
    ds_read_b32 v202, v226 offset:256
    ds_read_b32 v206, v226 offset:384
    s_branch K2_NQv0
K2_OQv0:
    ds_read_b32 v195, v226 offset:0
    ds_read_b32 v199, v226 offset:128
    ds_read_b32 v203, v226 offset:256
    ds_read_b32 v207, v226 offset:384
K2_NQv0:
    v_lshl_add_u64 v[224:225], v[224:225], 0, s[56:57]
    v_rcp_f32 v122, v92
    v_rcp_f32 v123, v93
    v_max3_f32 v235, v235, v92, v93
    v_pk_add_f32 v[120:121], v[64:65], v[228:229]
    v_pk_mul_f32 v[124:125], v[84:85], v[122:123]
    v_add_f32 v127, v124, v125
    v_cvt_f64_f32 v[124:125], v127
    ds_add_f64 v233, v[124:125] offset:512
    v_pk_fma_f32 v[84:85], v[32:33], v[66:67], v[32:33]
    v_pk_fma_f32 v[92:93], v[120:121], v[66:67], v[120:121]
    v_pk_fma_f32 v[84:85], v[34:35], v[120:121], v[84:85]
    v_pk_fma_f32 v[84:85], v[84:85], v[68:69], v[84:85]
    v_pk_fma_f32 v[120:121], v[92:93], v[68:69], v[92:93]
    v_pk_fma_f32 v[84:85], v[36:37], v[92:93], v[84:85]
    v_pk_fma_f32 v[84:85], v[84:85], v[70:71], v[84:85]
    v_pk_fma_f32 v[92:93], v[120:121], v[70:71], v[120:121]
    v_pk_fma_f32 v[84:85], v[38:39], v[120:121], v[84:85]
    v_pk_fma_f32 v[84:85], v[84:85], v[72:73], v[84:85]
    v_pk_fma_f32 v[120:121], v[92:93], v[72:73], v[92:93]
    v_pk_fma_f32 v[84:85], v[40:41], v[92:93], v[84:85]
    v_pk_fma_f32 v[84:85], v[84:85], v[74:75], v[84:85]
    v_pk_fma_f32 v[92:93], v[120:121], v[74:75], v[120:121]
    v_pk_fma_f32 v[84:85], v[42:43], v[120:121], v[84:85]
    v_pk_fma_f32 v[84:85], v[84:85], v[76:77], v[84:85]
    v_pk_fma_f32 v[120:121], v[92:93], v[76:77], v[92:93]
    v_pk_fma_f32 v[84:85], v[44:45], v[92:93], v[84:85]
    v_pk_fma_f32 v[84:85], v[84:85], v[78:79], v[84:85]
    v_pk_fma_f32 v[92:93], v[120:121], v[78:79], v[120:121]
    v_pk_fma_f32 v[84:85], v[46:47], v[120:121], v[84:85]
    s_waitcnt lgkmcnt(0)
    v_add_u32 v236, 1, v236
    buffer_load_dwordx4 v[208:209], s[4:7], 0 idxen offen offset:0 lds
    buffer_load_dwordx4 v[210:211], s[4:7], 0 idxen offen offset:1024 lds
    ds_write_b32 v231, v236
    v_cmp_gt_u32 vcc, v236, v232
    buffer_load_dwordx4 v[212:213], s[4:7], 0 idxen offen offset:2048 lds
    buffer_load_dwordx4 v[214:215], s[4:7], 0 idxen offen offset:3072 lds
    buffer_load_dwordx2 v[116:117], v117, s[8:11], 0 offen
    s_setprio 0
    s_cbranch_vccnz K2_PDv0
    s_setprio 1
K2_PDv0:
    v_mfma_f32_32x32x16_bf16 v[32:47], v[96:99], v[128:131], 0
    v_exp_f32 v64, v48
    v_exp_f32 v65, v49
    v_exp_f32 v66, v50
    v_mfma_f32_32x32x16_bf16 v[32:47], v[100:103], v[132:135], v[32:47]
    v_exp_f32 v67, v51
    v_exp_f32 v68, v52
    v_exp_f32 v69, v53
    v_mfma_f32_32x32x16_bf16 v[32:47], v[104:107], v[136:139], v[32:47]
    v_exp_f32 v70, v54
    v_exp_f32 v71, v55
    v_exp_f32 v72, v56
    v_mfma_f32_32x32x16_bf16 v[32:47], v[108:111], v[140:143], v[32:47]
    v_exp_f32 v73, v57
    v_exp_f32 v74, v58
    v_exp_f32 v75, v59
    v_mfma_f32_32x32x16_bf16 v[32:47], v[112:115], v[192:195], v[32:47]
    v_exp_f32 v76, v60
    v_exp_f32 v77, v61
    v_exp_f32 v78, v62
    v_exp_f32 v79, v63
    v_rcp_f32 v122, v94
    v_rcp_f32 v123, v95
    v_max3_f32 v235, v235, v94, v95
    v_pk_add_f32 v[120:121], v[64:65], v[228:229]
    v_pk_mul_f32 v[124:125], v[86:87], v[122:123]
    v_add_f32 v127, v124, v125
    v_cvt_f64_f32 v[124:125], v127
    ds_add_f64 v233, v[124:125] offset:768
    v_pk_fma_f32 v[86:87], v[48:49], v[66:67], v[48:49]
    v_pk_fma_f32 v[94:95], v[120:121], v[66:67], v[120:121]
    v_pk_fma_f32 v[86:87], v[50:51], v[120:121], v[86:87]
    v_pk_fma_f32 v[86:87], v[86:87], v[68:69], v[86:87]
    v_pk_fma_f32 v[120:121], v[94:95], v[68:69], v[94:95]
    v_pk_fma_f32 v[86:87], v[52:53], v[94:95], v[86:87]
    v_pk_fma_f32 v[86:87], v[86:87], v[70:71], v[86:87]
    v_pk_fma_f32 v[94:95], v[120:121], v[70:71], v[120:121]
    v_pk_fma_f32 v[86:87], v[54:55], v[120:121], v[86:87]
    v_pk_fma_f32 v[86:87], v[86:87], v[72:73], v[86:87]
    v_pk_fma_f32 v[120:121], v[94:95], v[72:73], v[94:95]
    v_pk_fma_f32 v[86:87], v[56:57], v[94:95], v[86:87]
    v_pk_fma_f32 v[86:87], v[86:87], v[74:75], v[86:87]
    v_pk_fma_f32 v[94:95], v[120:121], v[74:75], v[120:121]
    v_pk_fma_f32 v[86:87], v[58:59], v[120:121], v[86:87]
    v_pk_fma_f32 v[86:87], v[86:87], v[76:77], v[86:87]
    v_pk_fma_f32 v[120:121], v[94:95], v[76:77], v[94:95]
    v_pk_fma_f32 v[86:87], v[60:61], v[94:95], v[86:87]
    v_pk_fma_f32 v[86:87], v[86:87], v[78:79], v[86:87]
    v_pk_fma_f32 v[94:95], v[120:121], v[78:79], v[120:121]
    v_pk_fma_f32 v[86:87], v[62:63], v[120:121], v[86:87]
    s_cmp_ge_u32 s54, s24
    s_cbranch_scc1 K2_FLUSH
    s_cmp_eq_u32 s28, 8
    s_cbranch_scc1 K2_V8
    s_branch K2_DO
    .p2align 6
K2_V2:
    v_lshl_add_u32 v233, s27, 1, v223
    s_mov_b32 s27, s30
    v_mfma_f32_32x32x16_bf16 v[48:63], v[96:99], v[144:147], 0
    v_exp_f32 v64, v32
    v_exp_f32 v65, v33
    v_exp_f32 v66, v34
    v_mfma_f32_32x32x16_bf16 v[48:63], v[100:103], v[148:151], v[48:63]
    v_exp_f32 v67, v35
    v_exp_f32 v68, v36
    v_exp_f32 v69, v37
    v_mfma_f32_32x32x16_bf16 v[48:63], v[104:107], v[152:155], v[48:63]
    v_exp_f32 v70, v38
    v_exp_f32 v71, v39
    v_exp_f32 v72, v40
    v_mfma_f32_32x32x16_bf16 v[48:63], v[108:111], v[156:159], v[48:63]
    v_exp_f32 v73, v41
    v_exp_f32 v74, v42
    v_exp_f32 v75, v43
    v_mfma_f32_32x32x16_bf16 v[48:63], v[112:115], v[196:199], v[48:63]
    v_exp_f32 v76, v44
    v_exp_f32 v77, v45
    v_exp_f32 v78, v46
    v_exp_f32 v79, v47
    v_pk_fma_f32 v[80:81], v[80:81], v[64:65], v[80:81]
    s_add_u32 s54, s54, 32
    v_pk_fma_f32 v[120:121], v[88:89], v[64:65], v[88:89]
    s_sub_i32 s44, s35, s54
    v_pk_fma_f32 v[80:81], v[32:33], v[88:89], v[80:81]
    s_lshr_b32 s45, s44, 2
    v_pk_fma_f32 v[80:81], v[80:81], v[66:67], v[80:81]
    s_cmp_lt_i32 s44, 32
    v_pk_fma_f32 v[88:89], v[120:121], v[66:67], v[120:121]
    s_cselect_b32 s28, s45, 8
    v_pk_fma_f32 v[80:81], v[34:35], v[120:121], v[80:81]
    s_addc_u32 s55, s55, 0
    v_rcp_f32 v122, v88
    v_rcp_f32 v123, v89
    v_max3_f32 v235, v235, v88, v89
    v_pk_add_f32 v[120:121], v[68:69], v[228:229]
    s_lshl_b32 s30, s55, 9
    v_pk_mul_f32 v[124:125], v[80:81], v[122:123]
    v_readlane_b32 s35, v237, s55
    v_add_f32 v127, v124, v125
    v_cvt_f64_f32 v[124:125], v127
    ds_add_f64 v233, v[124:125] offset:0
    v_pk_fma_f32 v[80:81], v[36:37], v[70:71], v[36:37]
    v_pk_fma_f32 v[88:89], v[120:121], v[70:71], v[120:121]
    v_pk_fma_f32 v[80:81], v[38:39], v[120:121], v[80:81]
    v_pk_fma_f32 v[80:81], v[80:81], v[72:73], v[80:81]
    v_pk_fma_f32 v[120:121], v[88:89], v[72:73], v[88:89]
    v_pk_fma_f32 v[80:81], v[40:41], v[88:89], v[80:81]
    v_pk_fma_f32 v[80:81], v[80:81], v[74:75], v[80:81]
    v_pk_fma_f32 v[88:89], v[120:121], v[74:75], v[120:121]
    v_pk_fma_f32 v[80:81], v[42:43], v[120:121], v[80:81]
    v_pk_fma_f32 v[80:81], v[80:81], v[76:77], v[80:81]
    v_pk_fma_f32 v[120:121], v[88:89], v[76:77], v[88:89]
    v_pk_fma_f32 v[80:81], v[44:45], v[88:89], v[80:81]
    v_pk_fma_f32 v[80:81], v[80:81], v[78:79], v[80:81]
    v_pk_fma_f32 v[88:89], v[120:121], v[78:79], v[120:121]
    v_pk_fma_f32 v[80:81], v[46:47], v[120:121], v[80:81]
    v_mfma_f32_32x32x16_bf16 v[32:47], v[96:99], v[160:163], 0
    v_exp_f32 v64, v48
    v_exp_f32 v65, v49
    v_exp_f32 v66, v50
    v_mfma_f32_32x32x16_bf16 v[32:47], v[100:103], v[164:167], v[32:47]
    v_exp_f32 v67, v51
    v_exp_f32 v68, v52
    v_exp_f32 v69, v53
    v_mfma_f32_32x32x16_bf16 v[32:47], v[104:107], v[168:171], v[32:47]
    v_exp_f32 v70, v54
    v_exp_f32 v71, v55
    v_exp_f32 v72, v56
    v_mfma_f32_32x32x16_bf16 v[32:47], v[108:111], v[172:175], v[32:47]
    v_exp_f32 v73, v57
    v_exp_f32 v74, v58
    v_exp_f32 v75, v59
    v_mfma_f32_32x32x16_bf16 v[32:47], v[112:115], v[200:203], v[32:47]
    v_exp_f32 v76, v60
    v_exp_f32 v77, v61
    v_exp_f32 v78, v62
    v_exp_f32 v79, v63
    v_pk_fma_f32 v[82:83], v[82:83], v[64:65], v[82:83]
    v_pk_fma_f32 v[120:121], v[90:91], v[64:65], v[90:91]
    v_pk_fma_f32 v[82:83], v[48:49], v[90:91], v[82:83]
    v_pk_fma_f32 v[82:83], v[82:83], v[66:67], v[82:83]
    v_pk_fma_f32 v[90:91], v[120:121], v[66:67], v[120:121]
    v_pk_fma_f32 v[82:83], v[50:51], v[120:121], v[82:83]
    v_rcp_f32 v122, v90
    v_rcp_f32 v123, v91
    v_max3_f32 v235, v235, v90, v91
    v_pk_add_f32 v[120:121], v[68:69], v[228:229]
    v_pk_mul_f32 v[124:125], v[82:83], v[122:123]
    v_add_f32 v127, v124, v125
    v_cvt_f64_f32 v[124:125], v127
    ds_add_f64 v233, v[124:125] offset:256
    v_pk_fma_f32 v[82:83], v[52:53], v[70:71], v[52:53]
    v_pk_fma_f32 v[90:91], v[120:121], v[70:71], v[120:121]
    v_pk_fma_f32 v[82:83], v[54:55], v[120:121], v[82:83]
    v_pk_fma_f32 v[82:83], v[82:83], v[72:73], v[82:83]
    v_pk_fma_f32 v[120:121], v[90:91], v[72:73], v[90:91]
    v_pk_fma_f32 v[82:83], v[56:57], v[90:91], v[82:83]
    v_pk_fma_f32 v[82:83], v[82:83], v[74:75], v[82:83]
    v_pk_fma_f32 v[90:91], v[120:121], v[74:75], v[120:121]
    v_pk_fma_f32 v[82:83], v[58:59], v[120:121], v[82:83]
    v_pk_fma_f32 v[82:83], v[82:83], v[76:77], v[82:83]
    v_pk_fma_f32 v[120:121], v[90:91], v[76:77], v[90:91]
    v_pk_fma_f32 v[82:83], v[60:61], v[90:91], v[82:83]
    v_pk_fma_f32 v[82:83], v[82:83], v[78:79], v[82:83]
    v_pk_fma_f32 v[90:91], v[120:121], v[78:79], v[120:121]
    v_pk_fma_f32 v[82:83], v[62:63], v[120:121], v[82:83]
    v_mfma_f32_32x32x16_bf16 v[48:63], v[96:99], v[176:179], 0
    v_exp_f32 v64, v32
    v_exp_f32 v65, v33
    v_exp_f32 v66, v34
    v_mfma_f32_32x32x16_bf16 v[48:63], v[100:103], v[180:183], v[48:63]
    v_exp_f32 v67, v35
    v_exp_f32 v68, v36
    v_exp_f32 v69, v37
    v_mfma_f32_32x32x16_bf16 v[48:63], v[104:107], v[184:187], v[48:63]
    v_exp_f32 v70, v38
    v_exp_f32 v71, v39
    v_exp_f32 v72, v40
    v_mfma_f32_32x32x16_bf16 v[48:63], v[108:111], v[188:191], v[48:63]
    v_exp_f32 v73, v41
    v_exp_f32 v74, v42
    v_exp_f32 v75, v43
    v_mfma_f32_32x32x16_bf16 v[48:63], v[112:115], v[204:207], v[48:63]
    v_exp_f32 v76, v44
    v_exp_f32 v77, v45
    v_exp_f32 v78, v46
    v_exp_f32 v79, v47
    s_waitcnt vmcnt(0)
    ds_read_b128 v[96:99], v216
    ds_read_b128 v[100:103], v217
    ds_read_b128 v[104:107], v218
    ds_read_b128 v[108:111], v219
    v_pk_mov_b32 v[112:113], v[116:117], v[116:117] op_sel:[0,1]
    v_pk_mov_b32 v[114:115], v[118:119], v[118:119] op_sel:[0,1]
    ds_read_b128 v[116:119], v225
    ds_read_b32 v208, v224 offset:0
    ds_read_b32 v210, v224 offset:128
    ds_read_b32 v212, v224 offset:256
    ds_read_b32 v214, v224 offset:384
    ds_read_b32 v232, v230
    s_cmp_eq_u32 s28, 8
    s_cbranch_scc1 K2_NQv2
    v_add_u32 v226, s30, v222
    s_bitcmp1_b32 s30, 9
    s_cbranch_scc1 K2_OQv2
    ds_read_b32 v194, v226 offset:0
    ds_read_b32 v198, v226 offset:128
    ds_read_b32 v202, v226 offset:256
    ds_read_b32 v206, v226 offset:384
    s_branch K2_NQv2
K2_OQv2:
    ds_read_b32 v195, v226 offset:0
    ds_read_b32 v199, v226 offset:128
    ds_read_b32 v203, v226 offset:256
    ds_read_b32 v207, v226 offset:384
K2_NQv2:
    v_lshl_add_u64 v[224:225], v[224:225], 0, s[56:57]
    v_pk_fma_f32 v[84:85], v[84:85], v[64:65], v[84:85]
    v_pk_fma_f32 v[120:121], v[92:93], v[64:65], v[92:93]
    v_pk_fma_f32 v[84:85], v[32:33], v[92:93], v[84:85]
    v_pk_fma_f32 v[84:85], v[84:85], v[66:67], v[84:85]
    v_pk_fma_f32 v[92:93], v[120:121], v[66:67], v[120:121]
    v_pk_fma_f32 v[84:85], v[34:35], v[120:121], v[84:85]
    v_rcp_f32 v122, v92
    v_rcp_f32 v123, v93
    v_max3_f32 v235, v235, v92, v93
    v_pk_add_f32 v[120:121], v[68:69], v[228:229]
    v_pk_mul_f32 v[124:125], v[84:85], v[122:123]
    v_add_f32 v127, v124, v125
    v_cvt_f64_f32 v[124:125], v127
    ds_add_f64 v233, v[124:125] offset:512
    v_pk_fma_f32 v[84:85], v[36:37], v[70:71], v[36:37]
    v_pk_fma_f32 v[92:93], v[120:121], v[70:71], v[120:121]
    v_pk_fma_f32 v[84:85], v[38:39], v[120:121], v[84:85]
    v_pk_fma_f32 v[84:85], v[84:85], v[72:73], v[84:85]
    v_pk_fma_f32 v[120:121], v[92:93], v[72:73], v[92:93]
    v_pk_fma_f32 v[84:85], v[40:41], v[92:93], v[84:85]
    v_pk_fma_f32 v[84:85], v[84:85], v[74:75], v[84:85]
    v_pk_fma_f32 v[92:93], v[120:121], v[74:75], v[120:121]
    v_pk_fma_f32 v[84:85], v[42:43], v[120:121], v[84:85]
    v_pk_fma_f32 v[84:85], v[84:85], v[76:77], v[84:85]
    v_pk_fma_f32 v[120:121], v[92:93], v[76:77], v[92:93]
    v_pk_fma_f32 v[84:85], v[44:45], v[92:93], v[84:85]
    v_pk_fma_f32 v[84:85], v[84:85], v[78:79], v[84:85]
    v_pk_fma_f32 v[92:93], v[120:121], v[78:79], v[120:121]
    v_pk_fma_f32 v[84:85], v[46:47], v[120:121], v[84:85]
    s_waitcnt lgkmcnt(0)
    v_add_u32 v236, 1, v236
    buffer_load_dwordx4 v[208:209], s[4:7], 0 idxen offen offset:0 lds
    buffer_load_dwordx4 v[210:211], s[4:7], 0 idxen offen offset:1024 lds
    ds_write_b32 v231, v236
    v_cmp_gt_u32 vcc, v236, v232
    buffer_load_dwordx4 v[212:213], s[4:7], 0 idxen offen offset:2048 lds
    buffer_load_dwordx4 v[214:215], s[4:7], 0 idxen offen offset:3072 lds
    buffer_load_dwordx2 v[116:117], v117, s[8:11], 0 offen
    s_setprio 0
    s_cbranch_vccnz K2_PDv2
    s_setprio 1
K2_PDv2:
    v_mfma_f32_32x32x16_bf16 v[32:47], v[96:99], v[128:131], 0
    v_exp_f32 v64, v48
    v_exp_f32 v65, v49
    v_exp_f32 v66, v50
    v_mfma_f32_32x32x16_bf16 v[32:47], v[100:103], v[132:135], v[32:47]
    v_exp_f32 v67, v51
    v_exp_f32 v68, v52
    v_exp_f32 v69, v53
    v_mfma_f32_32x32x16_bf16 v[32:47], v[104:107], v[136:139], v[32:47]
    v_exp_f32 v70, v54
    v_exp_f32 v71, v55
    v_exp_f32 v72, v56
    v_mfma_f32_32x32x16_bf16 v[32:47], v[108:111], v[140:143], v[32:47]
    v_exp_f32 v73, v57
    v_exp_f32 v74, v58
    v_exp_f32 v75, v59
    v_mfma_f32_32x32x16_bf16 v[32:47], v[112:115], v[192:195], v[32:47]
    v_exp_f32 v76, v60
    v_exp_f32 v77, v61
    v_exp_f32 v78, v62
    v_exp_f32 v79, v63
    v_pk_fma_f32 v[86:87], v[86:87], v[64:65], v[86:87]
    v_pk_fma_f32 v[120:121], v[94:95], v[64:65], v[94:95]
    v_pk_fma_f32 v[86:87], v[48:49], v[94:95], v[86:87]
    v_pk_fma_f32 v[86:87], v[86:87], v[66:67], v[86:87]
    v_pk_fma_f32 v[94:95], v[120:121], v[66:67], v[120:121]
    v_pk_fma_f32 v[86:87], v[50:51], v[120:121], v[86:87]
    v_rcp_f32 v122, v94
    v_rcp_f32 v123, v95
    v_max3_f32 v235, v235, v94, v95
    v_pk_add_f32 v[120:121], v[68:69], v[228:229]
    v_pk_mul_f32 v[124:125], v[86:87], v[122:123]
    v_add_f32 v127, v124, v125
    v_cvt_f64_f32 v[124:125], v127
    ds_add_f64 v233, v[124:125] offset:768
    v_pk_fma_f32 v[86:87], v[52:53], v[70:71], v[52:53]
    v_pk_fma_f32 v[94:95], v[120:121], v[70:71], v[120:121]
    v_pk_fma_f32 v[86:87], v[54:55], v[120:121], v[86:87]
    v_pk_fma_f32 v[86:87], v[86:87], v[72:73], v[86:87]
    v_pk_fma_f32 v[120:121], v[94:95], v[72:73], v[94:95]
    v_pk_fma_f32 v[86:87], v[56:57], v[94:95], v[86:87]
    v_pk_fma_f32 v[86:87], v[86:87], v[74:75], v[86:87]
    v_pk_fma_f32 v[94:95], v[120:121], v[74:75], v[120:121]
    v_pk_fma_f32 v[86:87], v[58:59], v[120:121], v[86:87]
    v_pk_fma_f32 v[86:87], v[86:87], v[76:77], v[86:87]
    v_pk_fma_f32 v[120:121], v[94:95], v[76:77], v[94:95]
    v_pk_fma_f32 v[86:87], v[60:61], v[94:95], v[86:87]
    v_pk_fma_f32 v[86:87], v[86:87], v[78:79], v[86:87]
    v_pk_fma_f32 v[94:95], v[120:121], v[78:79], v[120:121]
    v_pk_fma_f32 v[86:87], v[62:63], v[120:121], v[86:87]
    s_cmp_ge_u32 s54, s24
    s_cbranch_scc1 K2_FLUSH
    s_cmp_eq_u32 s28, 8
    s_cbranch_scc1 K2_V8
    s_branch K2_DO
    .p2align 6
K2_V4:
    v_lshl_add_u32 v233, s27, 1, v223
    s_mov_b32 s27, s30
    v_mfma_f32_32x32x16_bf16 v[48:63], v[96:99], v[144:147], 0
    v_exp_f32 v64, v32
    v_exp_f32 v65, v33
    v_exp_f32 v66, v34
    v_mfma_f32_32x32x16_bf16 v[48:63], v[100:103], v[148:151], v[48:63]
    v_exp_f32 v67, v35
    v_exp_f32 v68, v36
    v_exp_f32 v69, v37
    v_mfma_f32_32x32x16_bf16 v[48:63], v[104:107], v[152:155], v[48:63]
    v_exp_f32 v70, v38
    v_exp_f32 v71, v39
    v_exp_f32 v72, v40
    v_mfma_f32_32x32x16_bf16 v[48:63], v[108:111], v[156:159], v[48:63]
    v_exp_f32 v73, v41
    v_exp_f32 v74, v42
    v_exp_f32 v75, v43
    v_mfma_f32_32x32x16_bf16 v[48:63], v[112:115], v[196:199], v[48:63]
    v_exp_f32 v76, v44
    v_exp_f32 v77, v45
    v_exp_f32 v78, v46
    v_exp_f32 v79, v47
    v_pk_fma_f32 v[80:81], v[80:81], v[64:65], v[80:81]
    s_add_u32 s54, s54, 32
    v_pk_fma_f32 v[120:121], v[88:89], v[64:65], v[88:89]
    s_sub_i32 s44, s35, s54
    v_pk_fma_f32 v[80:81], v[32:33], v[88:89], v[80:81]
    s_lshr_b32 s45, s44, 2
    v_pk_fma_f32 v[80:81], v[80:81], v[66:67], v[80:81]
    s_cmp_lt_i32 s44, 32
    v_pk_fma_f32 v[88:89], v[120:121], v[66:67], v[120:121]
    s_cselect_b32 s28, s45, 8
    v_pk_fma_f32 v[80:81], v[34:35], v[120:121], v[80:81]
    s_addc_u32 s55, s55, 0
    v_pk_fma_f32 v[80:81], v[80:81], v[68:69], v[80:81]
    s_lshl_b32 s30, s55, 9
    v_pk_fma_f32 v[120:121], v[88:89], v[68:69], v[88:89]
    v_readlane_b32 s35, v237, s55
    v_pk_fma_f32 v[80:81], v[36:37], v[88:89], v[80:81]
    v_pk_fma_f32 v[80:81], v[80:81], v[70:71], v[80:81]
    v_pk_fma_f32 v[88:89], v[120:121], v[70:71], v[120:121]
    v_pk_fma_f32 v[80:81], v[38:39], v[120:121], v[80:81]
    v_rcp_f32 v122, v88
    v_rcp_f32 v123, v89
    v_max3_f32 v235, v235, v88, v89
    v_pk_add_f32 v[120:121], v[72:73], v[228:229]
    v_pk_mul_f32 v[124:125], v[80:81], v[122:123]
    v_add_f32 v127, v124, v125
    v_cvt_f64_f32 v[124:125], v127
    ds_add_f64 v233, v[124:125] offset:0
    v_pk_fma_f32 v[80:81], v[40:41], v[74:75], v[40:41]
    v_pk_fma_f32 v[88:89], v[120:121], v[74:75], v[120:121]
    v_pk_fma_f32 v[80:81], v[42:43], v[120:121], v[80:81]
    v_pk_fma_f32 v[80:81], v[80:81], v[76:77], v[80:81]
    v_pk_fma_f32 v[120:121], v[88:89], v[76:77], v[88:89]
    v_pk_fma_f32 v[80:81], v[44:45], v[88:89], v[80:81]
    v_pk_fma_f32 v[80:81], v[80:81], v[78:79], v[80:81]
    v_pk_fma_f32 v[88:89], v[120:121], v[78:79], v[120:121]
    v_pk_fma_f32 v[80:81], v[46:47], v[120:121], v[80:81]
    v_mfma_f32_32x32x16_bf16 v[32:47], v[96:99], v[160:163], 0
    v_exp_f32 v64, v48
    v_exp_f32 v65, v49
    v_exp_f32 v66, v50
    v_mfma_f32_32x32x16_bf16 v[32:47], v[100:103], v[164:167], v[32:47]
    v_exp_f32 v67, v51
    v_exp_f32 v68, v52
    v_exp_f32 v69, v53
    v_mfma_f32_32x32x16_bf16 v[32:47], v[104:107], v[168:171], v[32:47]
    v_exp_f32 v70, v54
    v_exp_f32 v71, v55
    v_exp_f32 v72, v56
    v_mfma_f32_32x32x16_bf16 v[32:47], v[108:111], v[172:175], v[32:47]
    v_exp_f32 v73, v57
    v_exp_f32 v74, v58
    v_exp_f32 v75, v59
    v_mfma_f32_32x32x16_bf16 v[32:47], v[112:115], v[200:203], v[32:47]
    v_exp_f32 v76, v60
    v_exp_f32 v77, v61
    v_exp_f32 v78, v62
    v_exp_f32 v79, v63
    v_pk_fma_f32 v[82:83], v[82:83], v[64:65], v[82:83]
    v_pk_fma_f32 v[120:121], v[90:91], v[64:65], v[90:91]
    v_pk_fma_f32 v[82:83], v[48:49], v[90:91], v[82:83]
    v_pk_fma_f32 v[82:83], v[82:83], v[66:67], v[82:83]
    v_pk_fma_f32 v[90:91], v[120:121], v[66:67], v[120:121]
    v_pk_fma_f32 v[82:83], v[50:51], v[120:121], v[82:83]
    v_pk_fma_f32 v[82:83], v[82:83], v[68:69], v[82:83]
    v_pk_fma_f32 v[120:121], v[90:91], v[68:69], v[90:91]
    v_pk_fma_f32 v[82:83], v[52:53], v[90:91], v[82:83]
    v_pk_fma_f32 v[82:83], v[82:83], v[70:71], v[82:83]
    v_pk_fma_f32 v[90:91], v[120:121], v[70:71], v[120:121]
    v_pk_fma_f32 v[82:83], v[54:55], v[120:121], v[82:83]
    v_rcp_f32 v122, v90
    v_rcp_f32 v123, v91
    v_max3_f32 v235, v235, v90, v91
    v_pk_add_f32 v[120:121], v[72:73], v[228:229]
    v_pk_mul_f32 v[124:125], v[82:83], v[122:123]
    v_add_f32 v127, v124, v125
    v_cvt_f64_f32 v[124:125], v127
    ds_add_f64 v233, v[124:125] offset:256
    v_pk_fma_f32 v[82:83], v[56:57], v[74:75], v[56:57]
    v_pk_fma_f32 v[90:91], v[120:121], v[74:75], v[120:121]
    v_pk_fma_f32 v[82:83], v[58:59], v[120:121], v[82:83]
    v_pk_fma_f32 v[82:83], v[82:83], v[76:77], v[82:83]
    v_pk_fma_f32 v[120:121], v[90:91], v[76:77], v[90:91]
    v_pk_fma_f32 v[82:83], v[60:61], v[90:91], v[82:83]
    v_pk_fma_f32 v[82:83], v[82:83], v[78:79], v[82:83]
    v_pk_fma_f32 v[90:91], v[120:121], v[78:79], v[120:121]
    v_pk_fma_f32 v[82:83], v[62:63], v[120:121], v[82:83]
    v_mfma_f32_32x32x16_bf16 v[48:63], v[96:99], v[176:179], 0
    v_exp_f32 v64, v32
    v_exp_f32 v65, v33
    v_exp_f32 v66, v34
    v_mfma_f32_32x32x16_bf16 v[48:63], v[100:103], v[180:183], v[48:63]
    v_exp_f32 v67, v35
    v_exp_f32 v68, v36
    v_exp_f32 v69, v37
    v_mfma_f32_32x32x16_bf16 v[48:63], v[104:107], v[184:187], v[48:63]
    v_exp_f32 v70, v38
    v_exp_f32 v71, v39
    v_exp_f32 v72, v40
    v_mfma_f32_32x32x16_bf16 v[48:63], v[108:111], v[188:191], v[48:63]
    v_exp_f32 v73, v41
    v_exp_f32 v74, v42
    v_exp_f32 v75, v43
    v_mfma_f32_32x32x16_bf16 v[48:63], v[112:115], v[204:207], v[48:63]
    v_exp_f32 v76, v44
    v_exp_f32 v77, v45
    v_exp_f32 v78, v46
    v_exp_f32 v79, v47
    s_waitcnt vmcnt(0)
    ds_read_b128 v[96:99], v216
    ds_read_b128 v[100:103], v217
    ds_read_b128 v[104:107], v218
    ds_read_b128 v[108:111], v219
    v_pk_mov_b32 v[112:113], v[116:117], v[116:117] op_sel:[0,1]
    v_pk_mov_b32 v[114:115], v[118:119], v[118:119] op_sel:[0,1]
    ds_read_b128 v[116:119], v225
    ds_read_b32 v208, v224 offset:0
    ds_read_b32 v210, v224 offset:128
    ds_read_b32 v212, v224 offset:256
    ds_read_b32 v214, v224 offset:384
    ds_read_b32 v232, v230
    s_cmp_eq_u32 s28, 8
    s_cbranch_scc1 K2_NQv4
    v_add_u32 v226, s30, v222
    s_bitcmp1_b32 s30, 9
    s_cbranch_scc1 K2_OQv4
    ds_read_b32 v194, v226 offset:0
    ds_read_b32 v198, v226 offset:128
    ds_read_b32 v202, v226 offset:256
    ds_read_b32 v206, v226 offset:384
    s_branch K2_NQv4
K2_OQv4:
    ds_read_b32 v195, v226 offset:0
    ds_read_b32 v199, v226 offset:128
    ds_read_b32 v203, v226 offset:256
    ds_read_b32 v207, v226 offset:384
K2_NQv4:
    v_lshl_add_u64 v[224:225], v[224:225], 0, s[56:57]
    v_pk_fma_f32 v[84:85], v[84:85], v[64:65], v[84:85]
    v_pk_fma_f32 v[120:121], v[92:93], v[64:65], v[92:93]
    v_pk_fma_f32 v[84:85], v[32:33], v[92:93], v[84:85]
    v_pk_fma_f32 v[84:85], v[84:85], v[66:67], v[84:85]
    v_pk_fma_f32 v[92:93], v[120:121], v[66:67], v[120:121]
    v_pk_fma_f32 v[84:85], v[34:35], v[120:121], v[84:85]
    v_pk_fma_f32 v[84:85], v[84:85], v[68:69], v[84:85]
    v_pk_fma_f32 v[120:121], v[92:93], v[68:69], v[92:93]
    v_pk_fma_f32 v[84:85], v[36:37], v[92:93], v[84:85]
    v_pk_fma_f32 v[84:85], v[84:85], v[70:71], v[84:85]
    v_pk_fma_f32 v[92:93], v[120:121], v[70:71], v[120:121]
    v_pk_fma_f32 v[84:85], v[38:39], v[120:121], v[84:85]
    v_rcp_f32 v122, v92
    v_rcp_f32 v123, v93
    v_max3_f32 v235, v235, v92, v93
    v_pk_add_f32 v[120:121], v[72:73], v[228:229]
    v_pk_mul_f32 v[124:125], v[84:85], v[122:123]
    v_add_f32 v127, v124, v125
    v_cvt_f64_f32 v[124:125], v127
    ds_add_f64 v233, v[124:125] offset:512
    v_pk_fma_f32 v[84:85], v[40:41], v[74:75], v[40:41]
    v_pk_fma_f32 v[92:93], v[120:121], v[74:75], v[120:121]
    v_pk_fma_f32 v[84:85], v[42:43], v[120:121], v[84:85]
    v_pk_fma_f32 v[84:85], v[84:85], v[76:77], v[84:85]
    v_pk_fma_f32 v[120:121], v[92:93], v[76:77], v[92:93]
    v_pk_fma_f32 v[84:85], v[44:45], v[92:93], v[84:85]
    v_pk_fma_f32 v[84:85], v[84:85], v[78:79], v[84:85]
    v_pk_fma_f32 v[92:93], v[120:121], v[78:79], v[120:121]
    v_pk_fma_f32 v[84:85], v[46:47], v[120:121], v[84:85]
    s_waitcnt lgkmcnt(0)
    v_add_u32 v236, 1, v236
    buffer_load_dwordx4 v[208:209], s[4:7], 0 idxen offen offset:0 lds
    buffer_load_dwordx4 v[210:211], s[4:7], 0 idxen offen offset:1024 lds
    ds_write_b32 v231, v236
    v_cmp_gt_u32 vcc, v236, v232
    buffer_load_dwordx4 v[212:213], s[4:7], 0 idxen offen offset:2048 lds
    buffer_load_dwordx4 v[214:215], s[4:7], 0 idxen offen offset:3072 lds
    buffer_load_dwordx2 v[116:117], v117, s[8:11], 0 offen
    s_setprio 0
    s_cbranch_vccnz K2_PDv4
    s_setprio 1
K2_PDv4:
    v_mfma_f32_32x32x16_bf16 v[32:47], v[96:99], v[128:131], 0
    v_exp_f32 v64, v48
    v_exp_f32 v65, v49
    v_exp_f32 v66, v50
    v_mfma_f32_32x32x16_bf16 v[32:47], v[100:103], v[132:135], v[32:47]
    v_exp_f32 v67, v51
    v_exp_f32 v68, v52
    v_exp_f32 v69, v53
    v_mfma_f32_32x32x16_bf16 v[32:47], v[104:107], v[136:139], v[32:47]
    v_exp_f32 v70, v54
    v_exp_f32 v71, v55
    v_exp_f32 v72, v56
    v_mfma_f32_32x32x16_bf16 v[32:47], v[108:111], v[140:143], v[32:47]
    v_exp_f32 v73, v57
    v_exp_f32 v74, v58
    v_exp_f32 v75, v59
    v_mfma_f32_32x32x16_bf16 v[32:47], v[112:115], v[192:195], v[32:47]
    v_exp_f32 v76, v60
    v_exp_f32 v77, v61
    v_exp_f32 v78, v62
    v_exp_f32 v79, v63
    v_pk_fma_f32 v[86:87], v[86:87], v[64:65], v[86:87]
    v_pk_fma_f32 v[120:121], v[94:95], v[64:65], v[94:95]
    v_pk_fma_f32 v[86:87], v[48:49], v[94:95], v[86:87]
    v_pk_fma_f32 v[86:87], v[86:87], v[66:67], v[86:87]
    v_pk_fma_f32 v[94:95], v[120:121], v[66:67], v[120:121]
    v_pk_fma_f32 v[86:87], v[50:51], v[120:121], v[86:87]
    v_pk_fma_f32 v[86:87], v[86:87], v[68:69], v[86:87]
    v_pk_fma_f32 v[120:121], v[94:95], v[68:69], v[94:95]
    v_pk_fma_f32 v[86:87], v[52:53], v[94:95], v[86:87]
    v_pk_fma_f32 v[86:87], v[86:87], v[70:71], v[86:87]
    v_pk_fma_f32 v[94:95], v[120:121], v[70:71], v[120:121]
    v_pk_fma_f32 v[86:87], v[54:55], v[120:121], v[86:87]
    v_rcp_f32 v122, v94
    v_rcp_f32 v123, v95
    v_max3_f32 v235, v235, v94, v95
    v_pk_add_f32 v[120:121], v[72:73], v[228:229]
    v_pk_mul_f32 v[124:125], v[86:87], v[122:123]
    v_add_f32 v127, v124, v125
    v_cvt_f64_f32 v[124:125], v127
    ds_add_f64 v233, v[124:125] offset:768
    v_pk_fma_f32 v[86:87], v[56:57], v[74:75], v[56:57]
    v_pk_fma_f32 v[94:95], v[120:121], v[74:75], v[120:121]
    v_pk_fma_f32 v[86:87], v[58:59], v[120:121], v[86:87]
    v_pk_fma_f32 v[86:87], v[86:87], v[76:77], v[86:87]
    v_pk_fma_f32 v[120:121], v[94:95], v[76:77], v[94:95]
    v_pk_fma_f32 v[86:87], v[60:61], v[94:95], v[86:87]
    v_pk_fma_f32 v[86:87], v[86:87], v[78:79], v[86:87]
    v_pk_fma_f32 v[94:95], v[120:121], v[78:79], v[120:121]
    v_pk_fma_f32 v[86:87], v[62:63], v[120:121], v[86:87]
    s_cmp_ge_u32 s54, s24
    s_cbranch_scc1 K2_FLUSH
    s_cmp_eq_u32 s28, 8
    s_cbranch_scc1 K2_V8
    s_branch K2_DO
    .p2align 6
K2_V6:
    v_lshl_add_u32 v233, s27, 1, v223
    s_mov_b32 s27, s30
    v_mfma_f32_32x32x16_bf16 v[48:63], v[96:99], v[144:147], 0
    v_exp_f32 v64, v32
    v_exp_f32 v65, v33
    v_exp_f32 v66, v34
    v_mfma_f32_32x32x16_bf16 v[48:63], v[100:103], v[148:151], v[48:63]
    v_exp_f32 v67, v35
    v_exp_f32 v68, v36
    v_exp_f32 v69, v37
    v_mfma_f32_32x32x16_bf16 v[48:63], v[104:107], v[152:155], v[48:63]
    v_exp_f32 v70, v38
    v_exp_f32 v71, v39
    v_exp_f32 v72, v40
    v_mfma_f32_32x32x16_bf16 v[48:63], v[108:111], v[156:159], v[48:63]
    v_exp_f32 v73, v41
    v_exp_f32 v74, v42
    v_exp_f32 v75, v43
    v_mfma_f32_32x32x16_bf16 v[48:63], v[112:115], v[196:199], v[48:63]
    v_exp_f32 v76, v44
    v_exp_f32 v77, v45
    v_exp_f32 v78, v46
    v_exp_f32 v79, v47
    v_pk_fma_f32 v[80:81], v[80:81], v[64:65], v[80:81]
    s_add_u32 s54, s54, 32
    v_pk_fma_f32 v[120:121], v[88:89], v[64:65], v[88:89]
    s_sub_i32 s44, s35, s54
    v_pk_fma_f32 v[80:81], v[32:33], v[88:89], v[80:81]
    s_lshr_b32 s45, s44, 2
    v_pk_fma_f32 v[80:81], v[80:81], v[66:67], v[80:81]
    s_cmp_lt_i32 s44, 32
    v_pk_fma_f32 v[88:89], v[120:121], v[66:67], v[120:121]
    s_cselect_b32 s28, s45, 8
    v_pk_fma_f32 v[80:81], v[34:35], v[120:121], v[80:81]
    s_addc_u32 s55, s55, 0
    v_pk_fma_f32 v[80:81], v[80:81], v[68:69], v[80:81]
    s_lshl_b32 s30, s55, 9
    v_pk_fma_f32 v[120:121], v[88:89], v[68:69], v[88:89]
    v_readlane_b32 s35, v237, s55
    v_pk_fma_f32 v[80:81], v[36:37], v[88:89], v[80:81]
    v_pk_fma_f32 v[80:81], v[80:81], v[70:71], v[80:81]
    v_pk_fma_f32 v[88:89], v[120:121], v[70:71], v[120:121]
    v_pk_fma_f32 v[80:81], v[38:39], v[120:121], v[80:81]
    v_pk_fma_f32 v[80:81], v[80:81], v[72:73], v[80:81]
    v_pk_fma_f32 v[120:121], v[88:89], v[72:73], v[88:89]
    v_pk_fma_f32 v[80:81], v[40:41], v[88:89], v[80:81]
    v_pk_fma_f32 v[80:81], v[80:81], v[74:75], v[80:81]
    v_pk_fma_f32 v[88:89], v[120:121], v[74:75], v[120:121]
    v_pk_fma_f32 v[80:81], v[42:43], v[120:121], v[80:81]
    v_rcp_f32 v122, v88
    v_rcp_f32 v123, v89
    v_max3_f32 v235, v235, v88, v89
    v_pk_add_f32 v[120:121], v[76:77], v[228:229]
    v_pk_mul_f32 v[124:125], v[80:81], v[122:123]
    v_add_f32 v127, v124, v125
    v_cvt_f64_f32 v[124:125], v127
    ds_add_f64 v233, v[124:125] offset:0
    v_pk_fma_f32 v[80:81], v[44:45], v[78:79], v[44:45]
    v_pk_fma_f32 v[88:89], v[120:121], v[78:79], v[120:121]
    v_pk_fma_f32 v[80:81], v[46:47], v[120:121], v[80:81]
    v_mfma_f32_32x32x16_bf16 v[32:47], v[96:99], v[160:163], 0
    v_exp_f32 v64, v48
    v_exp_f32 v65, v49
    v_exp_f32 v66, v50
    v_mfma_f32_32x32x16_bf16 v[32:47], v[100:103], v[164:167], v[32:47]
    v_exp_f32 v67, v51
    v_exp_f32 v68, v52
    v_exp_f32 v69, v53
    v_mfma_f32_32x32x16_bf16 v[32:47], v[104:107], v[168:171], v[32:47]
    v_exp_f32 v70, v54
    v_exp_f32 v71, v55
    v_exp_f32 v72, v56
    v_mfma_f32_32x32x16_bf16 v[32:47], v[108:111], v[172:175], v[32:47]
    v_exp_f32 v73, v57
    v_exp_f32 v74, v58
    v_exp_f32 v75, v59
    v_mfma_f32_32x32x16_bf16 v[32:47], v[112:115], v[200:203], v[32:47]
    v_exp_f32 v76, v60
    v_exp_f32 v77, v61
    v_exp_f32 v78, v62
    v_exp_f32 v79, v63
    v_pk_fma_f32 v[82:83], v[82:83], v[64:65], v[82:83]
    v_pk_fma_f32 v[120:121], v[90:91], v[64:65], v[90:91]
    v_pk_fma_f32 v[82:83], v[48:49], v[90:91], v[82:83]
    v_pk_fma_f32 v[82:83], v[82:83], v[66:67], v[82:83]
    v_pk_fma_f32 v[90:91], v[120:121], v[66:67], v[120:121]
    v_pk_fma_f32 v[82:83], v[50:51], v[120:121], v[82:83]
    v_pk_fma_f32 v[82:83], v[82:83], v[68:69], v[82:83]
    v_pk_fma_f32 v[120:121], v[90:91], v[68:69], v[90:91]
    v_pk_fma_f32 v[82:83], v[52:53], v[90:91], v[82:83]
    v_pk_fma_f32 v[82:83], v[82:83], v[70:71], v[82:83]
    v_pk_fma_f32 v[90:91], v[120:121], v[70:71], v[120:121]
    v_pk_fma_f32 v[82:83], v[54:55], v[120:121], v[82:83]
    v_pk_fma_f32 v[82:83], v[82:83], v[72:73], v[82:83]
    v_pk_fma_f32 v[120:121], v[90:91], v[72:73], v[90:91]
    v_pk_fma_f32 v[82:83], v[56:57], v[90:91], v[82:83]
    v_pk_fma_f32 v[82:83], v[82:83], v[74:75], v[82:83]
    v_pk_fma_f32 v[90:91], v[120:121], v[74:75], v[120:121]
    v_pk_fma_f32 v[82:83], v[58:59], v[120:121], v[82:83]
    v_rcp_f32 v122, v90
    v_rcp_f32 v123, v91
    v_max3_f32 v235, v235, v90, v91
    v_pk_add_f32 v[120:121], v[76:77], v[228:229]
    v_pk_mul_f32 v[124:125], v[82:83], v[122:123]
    v_add_f32 v127, v124, v125
    v_cvt_f64_f32 v[124:125], v127
    ds_add_f64 v233, v[124:125] offset:256
    v_pk_fma_f32 v[82:83], v[60:61], v[78:79], v[60:61]
    v_pk_fma_f32 v[90:91], v[120:121], v[78:79], v[120:121]
    v_pk_fma_f32 v[82:83], v[62:63], v[120:121], v[82:83]
    v_mfma_f32_32x32x16_bf16 v[48:63], v[96:99], v[176:179], 0
    v_exp_f32 v64, v32
    v_exp_f32 v65, v33
    v_exp_f32 v66, v34
    v_mfma_f32_32x32x16_bf16 v[48:63], v[100:103], v[180:183], v[48:63]
    v_exp_f32 v67, v35
    v_exp_f32 v68, v36
    v_exp_f32 v69, v37
    v_mfma_f32_32x32x16_bf16 v[48:63], v[104:107], v[184:187], v[48:63]
    v_exp_f32 v70, v38
    v_exp_f32 v71, v39
    v_exp_f32 v72, v40
    v_mfma_f32_32x32x16_bf16 v[48:63], v[108:111], v[188:191], v[48:63]
    v_exp_f32 v73, v41
    v_exp_f32 v74, v42
    v_exp_f32 v75, v43
    v_mfma_f32_32x32x16_bf16 v[48:63], v[112:115], v[204:207], v[48:63]
    v_exp_f32 v76, v44
    v_exp_f32 v77, v45
    v_exp_f32 v78, v46
    v_exp_f32 v79, v47
    s_waitcnt vmcnt(0)
    ds_read_b128 v[96:99], v216
    ds_read_b128 v[100:103], v217
    ds_read_b128 v[104:107], v218
    ds_read_b128 v[108:111], v219
    v_pk_mov_b32 v[112:113], v[116:117], v[116:117] op_sel:[0,1]
    v_pk_mov_b32 v[114:115], v[118:119], v[118:119] op_sel:[0,1]
    ds_read_b128 v[116:119], v225
    ds_read_b32 v208, v224 offset:0
    ds_read_b32 v210, v224 offset:128
    ds_read_b32 v212, v224 offset:256
    ds_read_b32 v214, v224 offset:384
    ds_read_b32 v232, v230
    s_cmp_eq_u32 s28, 8
    s_cbranch_scc1 K2_NQv6
    v_add_u32 v226, s30, v222
    s_bitcmp1_b32 s30, 9
    s_cbranch_scc1 K2_OQv6
    ds_read_b32 v194, v226 offset:0
    ds_read_b32 v198, v226 offset:128
    ds_read_b32 v202, v226 offset:256
    ds_read_b32 v206, v226 offset:384
    s_branch K2_NQv6
K2_OQv6:
    ds_read_b32 v195, v226 offset:0
    ds_read_b32 v199, v226 offset:128
    ds_read_b32 v203, v226 offset:256
    ds_read_b32 v207, v226 offset:384
K2_NQv6:
    v_lshl_add_u64 v[224:225], v[224:225], 0, s[56:57]
    v_pk_fma_f32 v[84:85], v[84:85], v[64:65], v[84:85]
    v_pk_fma_f32 v[120:121], v[92:93], v[64:65], v[92:93]
    v_pk_fma_f32 v[84:85], v[32:33], v[92:93], v[84:85]
    v_pk_fma_f32 v[84:85], v[84:85], v[66:67], v[84:85]
    v_pk_fma_f32 v[92:93], v[120:121], v[66:67], v[120:121]
    v_pk_fma_f32 v[84:85], v[34:35], v[120:121], v[84:85]
    v_pk_fma_f32 v[84:85], v[84:85], v[68:69], v[84:85]
    v_pk_fma_f32 v[120:121], v[92:93], v[68:69], v[92:93]
    v_pk_fma_f32 v[84:85], v[36:37], v[92:93], v[84:85]
    v_pk_fma_f32 v[84:85], v[84:85], v[70:71], v[84:85]
    v_pk_fma_f32 v[92:93], v[120:121], v[70:71], v[120:121]
    v_pk_fma_f32 v[84:85], v[38:39], v[120:121], v[84:85]
    v_pk_fma_f32 v[84:85], v[84:85], v[72:73], v[84:85]
    v_pk_fma_f32 v[120:121], v[92:93], v[72:73], v[92:93]
    v_pk_fma_f32 v[84:85], v[40:41], v[92:93], v[84:85]
    v_pk_fma_f32 v[84:85], v[84:85], v[74:75], v[84:85]
    v_pk_fma_f32 v[92:93], v[120:121], v[74:75], v[120:121]
    v_pk_fma_f32 v[84:85], v[42:43], v[120:121], v[84:85]
    v_rcp_f32 v122, v92
    v_rcp_f32 v123, v93
    v_max3_f32 v235, v235, v92, v93
    v_pk_add_f32 v[120:121], v[76:77], v[228:229]
    v_pk_mul_f32 v[124:125], v[84:85], v[122:123]
    v_add_f32 v127, v124, v125
    v_cvt_f64_f32 v[124:125], v127
    ds_add_f64 v233, v[124:125] offset:512
    v_pk_fma_f32 v[84:85], v[44:45], v[78:79], v[44:45]
    v_pk_fma_f32 v[92:93], v[120:121], v[78:79], v[120:121]
    v_pk_fma_f32 v[84:85], v[46:47], v[120:121], v[84:85]
    s_waitcnt lgkmcnt(0)
    v_add_u32 v236, 1, v236
    buffer_load_dwordx4 v[208:209], s[4:7], 0 idxen offen offset:0 lds
    buffer_load_dwordx4 v[210:211], s[4:7], 0 idxen offen offset:1024 lds
    ds_write_b32 v231, v236
    v_cmp_gt_u32 vcc, v236, v232
    buffer_load_dwordx4 v[212:213], s[4:7], 0 idxen offen offset:2048 lds
    buffer_load_dwordx4 v[214:215], s[4:7], 0 idxen offen offset:3072 lds
    buffer_load_dwordx2 v[116:117], v117, s[8:11], 0 offen
    s_setprio 0
    s_cbranch_vccnz K2_PDv6
    s_setprio 1
K2_PDv6:
    v_mfma_f32_32x32x16_bf16 v[32:47], v[96:99], v[128:131], 0
    v_exp_f32 v64, v48
    v_exp_f32 v65, v49
    v_exp_f32 v66, v50
    v_mfma_f32_32x32x16_bf16 v[32:47], v[100:103], v[132:135], v[32:47]
    v_exp_f32 v67, v51
    v_exp_f32 v68, v52
    v_exp_f32 v69, v53
    v_mfma_f32_32x32x16_bf16 v[32:47], v[104:107], v[136:139], v[32:47]
    v_exp_f32 v70, v54
    v_exp_f32 v71, v55
    v_exp_f32 v72, v56
    v_mfma_f32_32x32x16_bf16 v[32:47], v[108:111], v[140:143], v[32:47]
    v_exp_f32 v73, v57
    v_exp_f32 v74, v58
    v_exp_f32 v75, v59
    v_mfma_f32_32x32x16_bf16 v[32:47], v[112:115], v[192:195], v[32:47]
    v_exp_f32 v76, v60
    v_exp_f32 v77, v61
    v_exp_f32 v78, v62
    v_exp_f32 v79, v63
    v_pk_fma_f32 v[86:87], v[86:87], v[64:65], v[86:87]
    v_pk_fma_f32 v[120:121], v[94:95], v[64:65], v[94:95]
    v_pk_fma_f32 v[86:87], v[48:49], v[94:95], v[86:87]
    v_pk_fma_f32 v[86:87], v[86:87], v[66:67], v[86:87]
    v_pk_fma_f32 v[94:95], v[120:121], v[66:67], v[120:121]
    v_pk_fma_f32 v[86:87], v[50:51], v[120:121], v[86:87]
    v_pk_fma_f32 v[86:87], v[86:87], v[68:69], v[86:87]
    v_pk_fma_f32 v[120:121], v[94:95], v[68:69], v[94:95]
    v_pk_fma_f32 v[86:87], v[52:53], v[94:95], v[86:87]
    v_pk_fma_f32 v[86:87], v[86:87], v[70:71], v[86:87]
    v_pk_fma_f32 v[94:95], v[120:121], v[70:71], v[120:121]
    v_pk_fma_f32 v[86:87], v[54:55], v[120:121], v[86:87]
    v_pk_fma_f32 v[86:87], v[86:87], v[72:73], v[86:87]
    v_pk_fma_f32 v[120:121], v[94:95], v[72:73], v[94:95]
    v_pk_fma_f32 v[86:87], v[56:57], v[94:95], v[86:87]
    v_pk_fma_f32 v[86:87], v[86:87], v[74:75], v[86:87]
    v_pk_fma_f32 v[94:95], v[120:121], v[74:75], v[120:121]
    v_pk_fma_f32 v[86:87], v[58:59], v[120:121], v[86:87]
    v_rcp_f32 v122, v94
    v_rcp_f32 v123, v95
    v_max3_f32 v235, v235, v94, v95
    v_pk_add_f32 v[120:121], v[76:77], v[228:229]
    v_pk_mul_f32 v[124:125], v[86:87], v[122:123]
    v_add_f32 v127, v124, v125
    v_cvt_f64_f32 v[124:125], v127
    ds_add_f64 v233, v[124:125] offset:768
    v_pk_fma_f32 v[86:87], v[60:61], v[78:79], v[60:61]
    v_pk_fma_f32 v[94:95], v[120:121], v[78:79], v[120:121]
    v_pk_fma_f32 v[86:87], v[62:63], v[120:121], v[86:87]
    s_cmp_ge_u32 s54, s24
    s_cbranch_scc1 K2_FLUSH
    s_cmp_eq_u32 s28, 8
    s_cbranch_scc1 K2_V8
    s_branch K2_DO
K2_FLUSH:
    v_lshl_add_u32 v233, s27, 1, v223
    v_rcp_f32 v122, v88
    v_rcp_f32 v123, v89
    v_max3_f32 v235, v235, v88, v89
    s_nop 0
    v_pk_mul_f32 v[124:125], v[80:81], v[122:123]
    v_add_f32 v127, v124, v125
    v_cvt_f64_f32 v[124:125], v127
    ds_add_f64 v233, v[124:125] offset:0
    v_rcp_f32 v122, v90
    v_rcp_f32 v123, v91
    v_max3_f32 v235, v235, v90, v91
    s_nop 0
    v_pk_mul_f32 v[124:125], v[82:83], v[122:123]
    v_add_f32 v127, v124, v125
    v_cvt_f64_f32 v[124:125], v127
    ds_add_f64 v233, v[124:125] offset:256
    v_rcp_f32 v122, v92
    v_rcp_f32 v123, v93
    v_max3_f32 v235, v235, v92, v93
    s_nop 0
    v_pk_mul_f32 v[124:125], v[84:85], v[122:123]
    v_add_f32 v127, v124, v125
    v_cvt_f64_f32 v[124:125], v127
    ds_add_f64 v233, v[124:125] offset:512
    v_rcp_f32 v122, v94
    v_rcp_f32 v123, v95
    v_max3_f32 v235, v235, v94, v95
    s_nop 0
    v_pk_mul_f32 v[124:125], v[86:87], v[122:123]
    v_add_f32 v127, v124, v125
    v_cvt_f64_f32 v[124:125], v127
    ds_add_f64 v233, v[124:125] offset:768
K2_LOOPDONE:
    s_setprio 0
    v_mov_b32 v232, 0x7fffffff
    ds_write_b32 v231, v232
    v_cmp_lt_f32 vcc, s37, v235
    s_cmp_eq_u64 vcc, 0
    s_cbranch_scc1 K2_NOV
    v_mov_b32 v5, 163584
    v_mov_b32 v6, 1
    ds_write_b32 v5, v6 offset:4
K2_NOV:
    s_waitcnt vmcnt(0) lgkmcnt(0)
    s_cmp_ge_u32 s20, 4
    s_cbranch_scc1 K2_NW
    s_and_b32 s46, s20, 1
    s_lshl_b32 s47, s46, 13
    s_add_u32 s47, s47, 6852608
    v_lshlrev_b32 v4, 4, v1
    buffer_load_dwordx4 v[128:131], v4, s[12:15], s47 offen offset:0
    buffer_load_dwordx4 v[132:135], v4, s[12:15], s47 offen offset:1024
    buffer_load_dwordx4 v[136:139], v4, s[12:15], s47 offen offset:2048
    buffer_load_dwordx4 v[140:143], v4, s[12:15], s47 offen offset:3072
    s_add_u32 s47, s47, 4096
    buffer_load_dwordx4 v[144:147], v4, s[12:15], s47 offen offset:0
    buffer_load_dwordx4 v[148:151], v4, s[12:15], s47 offen offset:1024
    buffer_load_dwordx4 v[152:155], v4, s[12:15], s47 offen offset:2048
    buffer_load_dwordx4 v[156:159], v4, s[12:15], s47 offen offset:3072
    s_lshl_b32 s47, s46, 10
    s_add_u32 s47, s47, 6868992
    buffer_load_dwordx4 v[160:163], v4, s[12:15], s47 offen
K2_NW:
    s_barrier
    v_mov_b32 v5, 163584
    ds_read_b32 v6, v5 offset:4
    v_lshlrev_b32 v4, 5, v0
    v_add_u32 v4, 101376, v4
    ds_read_b128 v[52:55], v4 offset:0
    ds_read_b128 v[56:59], v4 offset:16
    ds_read_b128 v[60:63], v4 offset:16384
    ds_read_b128 v[64:67], v4 offset:16400
    s_cmp_ge_u32 s20, 4
    s_cbranch_scc1 K2_E0a
    ds_read_b128 v[68:71], v4 offset:32768
    ds_read_b128 v[72:75], v4 offset:32784
K2_E0a:
    s_mov_b32 s46, 0xbf317218
    v_lshrrev_b32 v5, 5, v0
    v_and_b32 v7, 31, v0
    v_lshlrev_b32 v7, 3, v7
    s_movk_i32 s47, 272
    v_mad_u32_u24 v5, v5, s47, v7
    s_waitcnt lgkmcnt(0)
    v_readfirstlane_b32 s47, v6
    s_cmp_lg_u32 s47, 0
    s_cbranch_scc1 K2_REDO
K2_EPI1:
    v_cvt_f32_f64 v32, v[52:53]
    v_cvt_f32_f64 v33, v[54:55]
    v_cvt_f32_f64 v34, v[56:57]
    v_cvt_f32_f64 v35, v[58:59]
    v_mul_f32 v32, s46, v32
    v_mul_f32 v33, s46, v33
    v_mul_f32 v34, s46, v34
    v_mul_f32 v35, s46, v35
    v_cvt_pk_bf16_f32 v44, v32, v33
    v_cvt_pk_bf16_f32 v45, v34, v35
    ds_write_b64 v5, v[44:45] offset:0
    v_lshlrev_b32 v46, 16, v44
    v_and_b32 v47, 0xffff0000, v44
    v_lshlrev_b32 v48, 16, v45
    v_and_b32 v49, 0xffff0000, v45
    v_sub_f32 v32, v32, v46
    v_sub_f32 v33, v33, v47
    v_sub_f32 v34, v34, v48
    v_sub_f32 v35, v35, v49
    v_cvt_pk_bf16_f32 v50, v32, v33
    v_cvt_pk_bf16_f32 v51, v34, v35
    ds_write_b64 v5, v[50:51] offset:17408
    v_cvt_f32_f64 v36, v[60:61]
    v_cvt_f32_f64 v37, v[62:63]
    v_cvt_f32_f64 v38, v[64:65]
    v_cvt_f32_f64 v39, v[66:67]
    v_mul_f32 v36, s46, v36
    v_mul_f32 v37, s46, v37
    v_mul_f32 v38, s46, v38
    v_mul_f32 v39, s46, v39
    v_cvt_pk_bf16_f32 v44, v36, v37
    v_cvt_pk_bf16_f32 v45, v38, v39
    ds_write_b64 v5, v[44:45] offset:4352
    v_lshlrev_b32 v46, 16, v44
    v_and_b32 v47, 0xffff0000, v44
    v_lshlrev_b32 v48, 16, v45
    v_and_b32 v49, 0xffff0000, v45
    v_sub_f32 v36, v36, v46
    v_sub_f32 v37, v37, v47
    v_sub_f32 v38, v38, v48
    v_sub_f32 v39, v39, v49
    v_cvt_pk_bf16_f32 v50, v36, v37
    v_cvt_pk_bf16_f32 v51, v38, v39
    ds_write_b64 v5, v[50:51] offset:21760
    s_cmp_ge_u32 s20, 4
    s_cbranch_scc1 K2_E2
    v_cvt_f32_f64 v40, v[68:69]
    v_cvt_f32_f64 v41, v[70:71]
    v_cvt_f32_f64 v42, v[72:73]
    v_cvt_f32_f64 v43, v[74:75]
    v_mul_f32 v40, s46, v40
    v_mul_f32 v41, s46, v41
    v_mul_f32 v42, s46, v42
    v_mul_f32 v43, s46, v43
    v_cvt_pk_bf16_f32 v44, v40, v41
    v_cvt_pk_bf16_f32 v45, v42, v43
    ds_write_b64 v5, v[44:45] offset:8704
    v_lshlrev_b32 v46, 16, v44
    v_and_b32 v47, 0xffff0000, v44
    v_lshlrev_b32 v48, 16, v45
    v_and_b32 v49, 0xffff0000, v45
    v_sub_f32 v40, v40, v46
    v_sub_f32 v41, v41, v47
    v_sub_f32 v42, v42, v48
    v_sub_f32 v43, v43, v49
    v_cvt_pk_bf16_f32 v50, v40, v41
    v_cvt_pk_bf16_f32 v51, v42, v43
    ds_write_b64 v5, v[50:51] offset:26112
K2_E2:
    s_waitcnt lgkmcnt(0)
    s_barrier
    s_cmp_ge_u32 s20, 4
    s_cbranch_scc1 K2_END
    v_and_b32 v2, 31, v1
    v_lshrrev_b32 v3, 5, v1
    s_lshr_b32 s46, s20, 1
    s_lshl_b32 s48, s46, 5
    v_add_u32 v7, s48, v2
    s_movk_i32 s47, 272
    v_mul_u32_u24 v4, s47, v7
    v_lshl_add_u32 v4, v3, 4, v4
    v_lshlrev_b32 v5, 2, v7
    v_add_u32 v5, 163328, v5
    ds_read_b32 v6, v5
    ds_read_b128 v[32:35], v4 offset:0
    ds_read_b128 v[36:39], v4 offset:32
    ds_read_b128 v[40:43], v4 offset:64
    ds_read_b128 v[44:47], v4 offset:96
    ds_read_b128 v[48:51], v4 offset:128
    ds_read_b128 v[52:55], v4 offset:160
    ds_read_b128 v[56:59], v4 offset:192
    ds_read_b128 v[60:63], v4 offset:224
    ds_read_b128 v[64:67], v4 offset:17408
    ds_read_b128 v[68:71], v4 offset:17440
    ds_read_b128 v[72:75], v4 offset:17472
    ds_read_b128 v[76:79], v4 offset:17504
    v_cmp_eq_u32 vcc, 0, v3
    s_waitcnt vmcnt(0) lgkmcnt(4)
    v_mfma_f32_32x32x16_bf16 v[112:127], v[128:131], v[32:35], 0
    ds_read_b128 v[80:83], v4 offset:17536
    v_mfma_f32_32x32x16_bf16 v[112:127], v[132:135], v[36:39], v[112:127]
    ds_read_b128 v[84:87], v4 offset:17568
    v_mfma_f32_32x32x16_bf16 v[112:127], v[136:139], v[40:43], v[112:127]
    ds_read_b128 v[88:91], v4 offset:17600
    v_mfma_f32_32x32x16_bf16 v[112:127], v[140:143], v[44:47], v[112:127]
    ds_read_b128 v[92:95], v4 offset:17632
    v_mfma_f32_32x32x16_bf16 v[112:127], v[144:147], v[48:51], v[112:127]
    v_cndmask_b32 v6, 0, v6, vcc
    v_and_b32 v96, 0xff, v6
    v_and_b32 v97, 0xff00, v6
    v_and_b32 v98, 0xff0000, v6
    v_mfma_f32_32x32x16_bf16 v[112:127], v[148:151], v[52:55], v[112:127]
    v_cvt_f32_u32 v96, v96
    v_cvt_f32_u32 v97, v97
    v_cvt_f32_u32 v98, v98
    v_mfma_f32_32x32x16_bf16 v[112:127], v[152:155], v[56:59], v[112:127]
    v_mov_b32 v102, 0
    v_mov_b32 v103, 0
    v_cvt_pk_bf16_f32 v100, v96, v97
    v_cvt_pk_bf16_f32 v101, v98, v102
    v_mfma_f32_32x32x16_bf16 v[112:127], v[156:159], v[60:63], v[112:127]
    s_waitcnt lgkmcnt(0)
    v_mfma_f32_32x32x16_bf16 v[112:127], v[128:131], v[64:67], v[112:127]
    v_mfma_f32_32x32x16_bf16 v[112:127], v[132:135], v[68:71], v[112:127]
    v_mfma_f32_32x32x16_bf16 v[112:127], v[136:139], v[72:75], v[112:127]
    v_mfma_f32_32x32x16_bf16 v[112:127], v[140:143], v[76:79], v[112:127]
    v_mfma_f32_32x32x16_bf16 v[112:127], v[144:147], v[80:83], v[112:127]
    v_mfma_f32_32x32x16_bf16 v[112:127], v[148:151], v[84:87], v[112:127]
    v_mfma_f32_32x32x16_bf16 v[112:127], v[152:155], v[88:91], v[112:127]
    v_mfma_f32_32x32x16_bf16 v[112:127], v[156:159], v[92:95], v[112:127]
    v_mfma_f32_32x32x16_bf16 v[112:127], v[160:163], v[100:103], v[112:127]
    s_mov_b32 s16, s62
    s_and_b32 s17, s63, 0xffff
    s_mov_b32 s18, 0x138800
    s_mov_b32 s19, 0x20000
    s_lshl_b32 s48, s21, 7
    s_and_b32 s49, s20, 1
    s_lshl_b32 s49, s49, 6
    s_add_u32 s48, s48, s49
    v_lshlrev_b32 v6, 7, v7
    v_lshl_add_u32 v6, v3, 4, v6
    v_cmp_gt_u32 vcc, s22, v7
    s_nop 7
    s_nop 2
    v_cvt_pk_bf16_f32 v32, v112, v113
    v_cvt_pk_bf16_f32 v33, v114, v115
    v_cvt_pk_bf16_f32 v34, v116, v117
    v_cvt_pk_bf16_f32 v35, v118, v119
    v_cvt_pk_bf16_f32 v36, v120, v121
    v_cvt_pk_bf16_f32 v37, v122, v123
    v_cvt_pk_bf16_f32 v38, v124, v125
    v_cvt_pk_bf16_f32 v39, v126, v127
    s_nop 1
    v_permlane32_swap_b32 v32, v34
    v_permlane32_swap_b32 v33, v35
    v_permlane32_swap_b32 v36, v38
    v_permlane32_swap_b32 v37, v39
    s_and_saveexec_b64 s[46:47], vcc
    s_cbranch_execz K2_E9
    buffer_store_dwordx4 v[32:35], v6, s[16:19], s48 offen
    buffer_store_dwordx4 v[36:39], v6, s[16:19], s48 offen offset:32
K2_E9:
K2_END:
    s_endpgm
K2_REDO:
    s_waitcnt vmcnt(0)
    s_barrier
    v_lshlrev_b32 v26, 4, v0
    v_add_u32 v26, 101376, v26
    v_mov_b32 v112, 0
    v_mov_b32 v113, 0
    v_mov_b32 v114, 0
    v_mov_b32 v115, 0
    ds_write_b128 v26, v[112:115] offset:0
    ds_write_b128 v26, v[112:115] offset:8192
    ds_write_b128 v26, v[112:115] offset:16384
    ds_write_b128 v26, v[112:115] offset:24576
    ds_write_b128 v26, v[112:115] offset:32768
    v_lshlrev_b32 v25, 4, v1
    s_mov_b32 s47, 6815744
    buffer_load_dwordx4 v[128:131], v25, s[12:15], s47 offen offset:0
    buffer_load_dwordx4 v[132:135], v25, s[12:15], s47 offen offset:1024
    buffer_load_dwordx4 v[136:139], v25, s[12:15], s47 offen offset:2048
    buffer_load_dwordx4 v[140:143], v25, s[12:15], s47 offen offset:3072
    s_add_u32 s47, s47, 4096
    buffer_load_dwordx4 v[144:147], v25, s[12:15], s47 offen offset:0
    buffer_load_dwordx4 v[148:151], v25, s[12:15], s47 offen offset:1024
    buffer_load_dwordx4 v[152:155], v25, s[12:15], s47 offen offset:2048
    buffer_load_dwordx4 v[156:159], v25, s[12:15], s47 offen offset:3072
    s_add_u32 s47, s47, 4096
    buffer_load_dwordx4 v[160:163], v25, s[12:15], s47 offen offset:0
    buffer_load_dwordx4 v[164:167], v25, s[12:15], s47 offen offset:1024
    buffer_load_dwordx4 v[168:171], v25, s[12:15], s47 offen offset:2048
    buffer_load_dwordx4 v[172:175], v25, s[12:15], s47 offen offset:3072
    s_add_u32 s47, s47, 4096
    buffer_load_dwordx4 v[176:179], v25, s[12:15], s47 offen offset:0
    buffer_load_dwordx4 v[180:183], v25, s[12:15], s47 offen offset:1024
    buffer_load_dwordx4 v[184:187], v25, s[12:15], s47 offen offset:2048
    buffer_load_dwordx4 v[188:191], v25, s[12:15], s47 offen offset:3072
    s_add_u32 s47, s47, 4096
    buffer_load_dwordx4 v[192:195], v25, s[12:15], s47 offen offset:0
    buffer_load_dwordx4 v[196:199], v25, s[12:15], s47 offen offset:1024
    buffer_load_dwordx4 v[200:203], v25, s[12:15], s47 offen offset:2048
    buffer_load_dwordx4 v[204:207], v25, s[12:15], s47 offen offset:3072
    s_waitcnt vmcnt(0) lgkmcnt(0)
    s_barrier
    s_add_u32 s46, s39, 31
    s_lshr_b32 s46, s46, 5
    s_lshr_b32 s47, s46, 3
    s_and_b32 s46, s46, 7
    s_mul_i32 s23, s47, s20
    s_min_u32 s48, s46, s20
    s_add_u32 s23, s23, s48
    s_add_u32 s24, s23, s47
    s_cmp_lt_u32 s20, s46
    s_addc_u32 s24, s24, 0
    s_mov_b32 s38, 0
    s_branch K2_SAFE
K2_SLOW:
    s_mov_b32 s38, 1
    s_mov_b32 s66, 0
    s_waitcnt lgkmcnt(0)
    s_barrier
    s_cmp_lg_u32 s20, 0
    s_cbranch_scc1 K2_SR
    v_lshlrev_b32 v4, 2, v1
    v_add_u32 v4, 163328, v4
    v_mov_b32 v5, 0
    ds_write_b32 v4, v5
K2_SR:
    s_cmp_ge_u32 s66, 1000
    s_cbranch_scc1 K2_EPI0
    s_lshr_b32 s67, s66, 2
    s_and_b32 s68, s66, 3
    s_add_u32 s66, s66, 1
    s_cmp_eq_u32 s68, 3
    s_cbranch_scc1 K2_SR
    s_lshl_b32 s46, s2, 14
    s_lshl_b32 s47, s67, 6
    s_add_u32 s54, s46, s47
    v_min_u32 v4, 15, v1
    v_lshlrev_b32 v4, 2, v4
    buffer_load_dword v5, v4, s[12:15], s54 offen
    s_mov_b32 s47, 0xa0000000
    s_waitcnt vmcnt(0)
    v_cmp_gt_u32 vcc, s47, v5
    v_readlane_b32 s55, v5, 15
    s_and_b32 s48, vcc_lo, 0xffff
    s_bcnt1_i32_b32 s69, s48
    s_cmp_eq_u32 s68, 0
    s_cbranch_scc1 K2_SR0
    s_add_u32 s47, s55, 1
    s_cmp_le_u32 s47, 0xf0000000
    s_cbranch_scc1 K2_SR
    s_and_b32 s69, s55, 0xfff
    s_lshr_b32 s47, s55, 12
    s_and_b32 s47, s47, 0xfff
    s_sub_u32 s48, s68, 1
    s_mul_i32 s48, s48, 1280
    s_cmp_le_u32 s69, s48
    s_cbranch_scc1 K2_SR
    s_sub_u32 s69, s69, s48
    s_min_u32 s69, s69, 1280
    s_add_u32 s47, s47, s48
    s_lshl_b32 s47, s47, 2
    s_mul_i32 s54, s67, 10240
    s_add_u32 s54, s54, s47
    s_add_u32 s54, s54, 4194304
K2_SR0:
    s_cmp_eq_u32 s69, 0
    s_cbranch_scc1 K2_SR
    s_waitcnt lgkmcnt(0)
    s_barrier
    v_cmp_gt_u32 vcc, 64, v0
    s_and_saveexec_b64 s[46:47], vcc
    s_cbranch_execz K2_I1
    v_lshlrev_b32 v27, 2, v0
    v_add_u32 v27, 162816, v27
    v_mov_b32 v5, 0
    ds_write_b32 v27, v5
K2_I1:
    s_mov_b64 exec, s[46:47]
    s_mov_b32 s46, s54
    v_lshlrev_b32 v4, 2, v0
    buffer_load_dword v32, v4, s[12:15], s46 offen
    buffer_load_dword v33, v4, s[12:15], s46 offen offset:2048
    v_add_u32 v5, 0x1000, v4
    buffer_load_dword v34, v5, s[12:15], s46 offen
    v_sub_u32 v28, s69, v0
    s_waitcnt vmcnt(0) lgkmcnt(0)
    s_barrier
    v_mov_b32 v7, 1
    s_mov_b32 s46, 162816
    v_and_b32 v64, 63, v32
    v_lshl_add_u32 v64, v64, 2, s46
    v_and_b32 v65, 63, v33
    v_lshl_add_u32 v65, v65, 2, s46
    v_and_b32 v66, 63, v34
    v_lshl_add_u32 v66, v66, 2, s46
    s_movk_i32 s47, 512
    s_movk_i32 s48, 1024
    v_cmpx_lt_i32 vcc, 0, v28
    ds_add_rtn_u32 v96, v64, v7
    v_cmpx_lt_i32 vcc, s47, v28
    ds_add_rtn_u32 v97, v65, v7
    v_cmpx_lt_i32 vcc, s48, v28
    ds_add_rtn_u32 v98, v66, v7
    s_mov_b64 exec, -1
    s_waitcnt lgkmcnt(0)
    s_barrier
    v_lshlrev_b32 v4, 2, v1
    v_add_u32 v4, 162816, v4
    ds_read_b32 v5, v4
    v_cmp_gt_u32 vcc, s22, v1
    s_waitcnt lgkmcnt(0)
    v_add_u32 v8, 3, v5
    v_and_b32 v8, -4, v8
    v_max_u32 v8, 32, v8
    v_cndmask_b32 v8, 0, v8, vcc
    v_mov_b32 v21, v8
    v_mov_b32 v12, 0x3fff
    v_mov_b32 v13, 0x7ffffff0
    v_add_u32_dpp v21, v21, v21 row_shr:1 row_mask:0xf bank_mask:0xf bound_ctrl:0
    v_mov_b32 v14, 0
    v_mov_b32 v15, 0
    v_add_u32_dpp v21, v21, v21 row_shr:2 row_mask:0xf bank_mask:0xf bound_ctrl:0
    v_mov_b32 v234, 0x7fffffff
    v_mov_b32 v237, 0x7fffffff
    v_add_u32_dpp v21, v21, v21 row_shr:4 row_mask:0xf bank_mask:0xf bound_ctrl:0
    v_mov_b32 v235, 0
    v_mov_b32 v236, 0
    v_add_u32_dpp v21, v21, v21 row_shr:8 row_mask:0xf bank_mask:0xf bound_ctrl:0
    v_and_b32 v10, 7, v1
    s_nop 0
    v_add_u32_dpp v21, v21, v21 row_bcast:15 row_mask:0xa bank_mask:0xf
    s_nop 1
    v_add_u32_dpp v21, v21, v21 row_bcast:31 row_mask:0xc bank_mask:0xf
    v_sub_u32 v22, v21, v8
    v_lshlrev_b32 v9, 4, v22
    ds_write_b32 v4, v9 offset:256
    v_readlane_b32 s39, v21, 63
    v_cndmask_b32 v234, v234, v22, vcc
    s_cmp_lg_u32 s20, 0
    s_cbranch_scc1 K2_DG2
    ds_add_u32 v4, v5 offset:512
K2_DG2:
    s_mul_i32 s46, s67, 20480
    v_mov_b32 v30, s46
    ds_read_b32 v64, v64 offset:256
    ds_read_b32 v65, v65 offset:256
    ds_read_b32 v66, v66 offset:256
    v_mov_b32 v238, 0x3f803f80
    s_movk_i32 s47, 512
    s_movk_i32 s48, 1024
    s_waitcnt lgkmcnt(0)
    v_cmpx_lt_i32 vcc, 0, v28
    v_bfe_i32 v4, v32, 0, 1
    v_bfe_u32 v16, v32, 6, 14
    v_lshrrev_b32 v17, 20, v32
    v_and_b32 v19, v238, v4
    v_lshl_add_u32 v17, v17, 3, v30
    v_xor_b32 v18, v238, v19
    v_lshl_add_u32 v20, v96, 4, v64
    ds_write_b128 v20, v[16:19]
    v_cmpx_lt_i32 vcc, s47, v28
    v_bfe_i32 v4, v33, 0, 1
    v_bfe_u32 v16, v33, 6, 14
    v_lshrrev_b32 v17, 20, v33
    v_and_b32 v19, v238, v4
    v_lshl_add_u32 v17, v17, 3, v30
    v_xor_b32 v18, v238, v19
    v_lshl_add_u32 v20, v97, 4, v65
    ds_write_b128 v20, v[16:19]
    v_cmpx_lt_i32 vcc, s48, v28
    v_bfe_i32 v4, v34, 0, 1
    v_bfe_u32 v16, v34, 6, 14
    v_lshrrev_b32 v17, 20, v34
    v_and_b32 v19, v238, v4
    v_lshl_add_u32 v17, v17, 3, v30
    v_xor_b32 v18, v238, v19
    v_lshl_add_u32 v20, v98, 4, v66
    ds_write_b128 v20, v[16:19]
    s_mov_b64 exec, -1
    s_cmp_ge_u32 s20, 2
    s_cbranch_scc1 K2_PTb
    s_lshl_b32 s46, s20, 6
    s_add_u32 s46, s46, s39
    v_add_lshl_u32 v11, s46, v1, 4
    s_cmp_eq_u32 s20, 1
    s_cselect_b32 exec_hi, 0, -1
    ds_write_b128 v11, v[12:15]
    s_mov_b64 exec, -1
K2_PTb:
    v_cmp_eq_u32 vcc, s20, v10
    v_sub_u32 v11, v8, v5
    v_lshl_add_u32 v10, v5, 4, v9
    v_cndmask_b32 v11, 0, v11, vcc
    v_cmpx_lt_i32 vcc, 0, v11
    ds_write_b128 v10, v[12:15] offset:0
    v_cmpx_lt_i32 vcc, 1, v11
    ds_write_b128 v10, v[12:15] offset:16
    v_cmpx_lt_i32 vcc, 2, v11
    ds_write_b128 v10, v[12:15] offset:32
    v_cmpx_lt_i32 vcc, 3, v11
    s_cbranch_execz K2_PEb
    v_add_u32 v10, 48, v10
    v_add_u32 v11, -3, v11
K2_PLb:
    ds_write_b128 v10, v[12:15]
    v_add_u32 v10, 16, v10
    v_add_u32 v11, -1, v11
    v_cmpx_lt_i32 vcc, 0, v11
    s_cbranch_execnz K2_PLb
K2_PEb:
    s_mov_b64 exec, -1
    s_add_u32 s46, s39, 31
    s_lshr_b32 s46, s46, 5
    s_lshr_b32 s47, s46, 3
    s_and_b32 s46, s46, 7
    s_mul_i32 s23, s47, s20
    s_min_u32 s48, s46, s20
    s_add_u32 s23, s23, s48
    s_add_u32 s24, s23, s47
    s_cmp_lt_u32 s20, s46
    s_addc_u32 s24, s24, 0
    s_waitcnt lgkmcnt(0)
    s_barrier
K2_SAFE:
    s_cmp_ge_u32 s23, s24
    s_cbranch_scc1 K2_SAFEDONE
    s_lshl_b32 s46, s23, 9
    v_add_u32 v224, s46, v220
    v_add_u32 v225, s46, v221
    s_mov_b32 m0, s36
K2_SFL:
    ds_read_b32 v208, v224 offset:0
    ds_read_b32 v210, v224 offset:128
    ds_read_b32 v212, v224 offset:256
    ds_read_b32 v214, v224 offset:384
    ds_read_b128 v[116:119], v225
    s_lshl_b32 s40, s23, 5
    s_add_u32 s41, s40, 31
    v_cmp_ge_u32 vcc, s41, v234
    s_bcnt1_i32_b64 s42, vcc
    s_sub_u32 s42, s42, 1
    s_max_i32 s42, s42, 0
    v_readlane_b32 s43, v234, s42
    s_sub_u32 s49, s42, 1
    s_max_i32 s49, s49, 0
    s_lshl_b32 s30, s42, 9
    s_sub_i32 s44, s43, s40
    s_lshr_b32 s45, s44, 2
    s_sub_i32 s46, 0, s44
    s_and_b32 s47, s46, 0x60
    s_cselect_b32 s47, 8, 0
    s_cmp_lt_u32 s46, 128
    s_cselect_b32 s47, 8, s47
    s_cmp_ge_i32 s44, 0
    s_cselect_b32 s28, s45, s47
    s_cselect_b32 s49, s49, s42
    s_lshl_b32 s29, s49, 9
    s_bitcmp1_b32 s49, 0
    s_cselect_b32 s31, s30, s29
    s_cselect_b32 s32, s29, s30
    v_add_u32 v224, 0x200, v224
    v_add_u32 v225, 0x200, v225
    s_waitcnt lgkmcnt(0)
    buffer_load_dwordx4 v[208:209], s[4:7], 0 idxen offen offset:0 lds
    buffer_load_dwordx4 v[210:211], s[4:7], 0 idxen offen offset:1024 lds
    buffer_load_dwordx4 v[212:213], s[4:7], 0 idxen offen offset:2048 lds
    buffer_load_dwordx4 v[214:215], s[4:7], 0 idxen offen offset:3072 lds
    buffer_load_dwordx2 v[116:117], v117, s[8:11], 0 offen
    v_add_u32 v226, s31, v222
    v_add_u32 v227, s32, v222
    s_waitcnt vmcnt(0)
    ds_read_b128 v[96:99], v216
    ds_read_b128 v[100:103], v217
    ds_read_b128 v[104:107], v218
    ds_read_b128 v[108:111], v219
    v_pk_mov_b32 v[112:113], v[116:117], v[116:117] op_sel:[0,1]
    v_pk_mov_b32 v[114:115], v[118:119], v[118:119] op_sel:[0,1]
    ds_read_b32 v194, v226 offset:0
    ds_read_b32 v195, v227 offset:0
    ds_read_b32 v198, v226 offset:128
    ds_read_b32 v199, v227 offset:128
    ds_read_b32 v202, v226 offset:256
    ds_read_b32 v203, v227 offset:256
    ds_read_b32 v206, v226 offset:384
    ds_read_b32 v207, v227 offset:384
    s_waitcnt lgkmcnt(0)
    v_mfma_f32_32x32x16_bf16 v[32:47], v[96:99], v[128:131], 0
    v_mfma_f32_32x32x16_bf16 v[32:47], v[100:103], v[132:135], v[32:47]
    v_mfma_f32_32x32x16_bf16 v[32:47], v[104:107], v[136:139], v[32:47]
    v_mfma_f32_32x32x16_bf16 v[32:47], v[108:111], v[140:143], v[32:47]
    v_mfma_f32_32x32x16_bf16 v[32:47], v[112:115], v[192:195], v[32:47]
    s_nop 7
    s_nop 7
    s_cmp_lt_u32 0, s28
    s_cselect_b32 s46, s29, s30
    v_lshl_add_u32 v233, s46, 1, v223
    v_exp_f32 v124, v32
    v_exp_f32 v125, v33
    s_nop 0
    v_add_f32 v124, 1.0, v124
    v_add_f32 v125, 1.0, v125
    v_rcp_f32 v124, v124
    v_rcp_f32 v125, v125
    s_nop 0
    v_mul_f32 v124, v32, v124
    v_mul_f32 v125, v33, v125
    v_add_f32 v126, v124, v125
    v_cvt_f64_f32 v[124:125], v126
    ds_add_f64 v233, v[124:125] offset:0
    s_cmp_lt_u32 1, s28
    s_cselect_b32 s46, s29, s30
    v_lshl_add_u32 v233, s46, 1, v223
    v_exp_f32 v124, v34
    v_exp_f32 v125, v35
    s_nop 0
    v_add_f32 v124, 1.0, v124
    v_add_f32 v125, 1.0, v125
    v_rcp_f32 v124, v124
    v_rcp_f32 v125, v125
    s_nop 0
    v_mul_f32 v124, v34, v124
    v_mul_f32 v125, v35, v125
    v_add_f32 v126, v124, v125
    v_cvt_f64_f32 v[124:125], v126
    ds_add_f64 v233, v[124:125] offset:0
    s_cmp_lt_u32 2, s28
    s_cselect_b32 s46, s29, s30
    v_lshl_add_u32 v233, s46, 1, v223
    v_exp_f32 v124, v36
    v_exp_f32 v125, v37
    s_nop 0
    v_add_f32 v124, 1.0, v124
    v_add_f32 v125, 1.0, v125
    v_rcp_f32 v124, v124
    v_rcp_f32 v125, v125
    s_nop 0
    v_mul_f32 v124, v36, v124
    v_mul_f32 v125, v37, v125
    v_add_f32 v126, v124, v125
    v_cvt_f64_f32 v[124:125], v126
    ds_add_f64 v233, v[124:125] offset:0
    s_cmp_lt_u32 3, s28
    s_cselect_b32 s46, s29, s30
    v_lshl_add_u32 v233, s46, 1, v223
    v_exp_f32 v124, v38
    v_exp_f32 v125, v39
    s_nop 0
    v_add_f32 v124, 1.0, v124
    v_add_f32 v125, 1.0, v125
    v_rcp_f32 v124, v124
    v_rcp_f32 v125, v125
    s_nop 0
    v_mul_f32 v124, v38, v124
    v_mul_f32 v125, v39, v125
    v_add_f32 v126, v124, v125
    v_cvt_f64_f32 v[124:125], v126
    ds_add_f64 v233, v[124:125] offset:0
    s_cmp_lt_u32 4, s28
    s_cselect_b32 s46, s29, s30
    v_lshl_add_u32 v233, s46, 1, v223
    v_exp_f32 v124, v40
    v_exp_f32 v125, v41
    s_nop 0
    v_add_f32 v124, 1.0, v124
    v_add_f32 v125, 1.0, v125
    v_rcp_f32 v124, v124
    v_rcp_f32 v125, v125
    s_nop 0
    v_mul_f32 v124, v40, v124
    v_mul_f32 v125, v41, v125
    v_add_f32 v126, v124, v125
    v_cvt_f64_f32 v[124:125], v126
    ds_add_f64 v233, v[124:125] offset:0
    s_cmp_lt_u32 5, s28
    s_cselect_b32 s46, s29, s30
    v_lshl_add_u32 v233, s46, 1, v223
    v_exp_f32 v124, v42
    v_exp_f32 v125, v43
    s_nop 0
    v_add_f32 v124, 1.0, v124
    v_add_f32 v125, 1.0, v125
    v_rcp_f32 v124, v124
    v_rcp_f32 v125, v125
    s_nop 0
    v_mul_f32 v124, v42, v124
    v_mul_f32 v125, v43, v125
    v_add_f32 v126, v124, v125
    v_cvt_f64_f32 v[124:125], v126
    ds_add_f64 v233, v[124:125] offset:0
    s_cmp_lt_u32 6, s28
    s_cselect_b32 s46, s29, s30
    v_lshl_add_u32 v233, s46, 1, v223
    v_exp_f32 v124, v44
    v_exp_f32 v125, v45
    s_nop 0
    v_add_f32 v124, 1.0, v124
    v_add_f32 v125, 1.0, v125
    v_rcp_f32 v124, v124
    v_rcp_f32 v125, v125
    s_nop 0
    v_mul_f32 v124, v44, v124
    v_mul_f32 v125, v45, v125
    v_add_f32 v126, v124, v125
    v_cvt_f64_f32 v[124:125], v126
    ds_add_f64 v233, v[124:125] offset:0
    s_cmp_lt_u32 7, s28
    s_cselect_b32 s46, s29, s30
    v_lshl_add_u32 v233, s46, 1, v223
    v_exp_f32 v124, v46
    v_exp_f32 v125, v47
    s_nop 0
    v_add_f32 v124, 1.0, v124
    v_add_f32 v125, 1.0, v125
    v_rcp_f32 v124, v124
    v_rcp_f32 v125, v125
    s_nop 0
    v_mul_f32 v124, v46, v124
    v_mul_f32 v125, v47, v125
    v_add_f32 v126, v124, v125
    v_cvt_f64_f32 v[124:125], v126
    ds_add_f64 v233, v[124:125] offset:0
    v_mfma_f32_32x32x16_bf16 v[32:47], v[96:99], v[144:147], 0
    v_mfma_f32_32x32x16_bf16 v[32:47], v[100:103], v[148:151], v[32:47]
    v_mfma_f32_32x32x16_bf16 v[32:47], v[104:107], v[152:155], v[32:47]
    v_mfma_f32_32x32x16_bf16 v[32:47], v[108:111], v[156:159], v[32:47]
    v_mfma_f32_32x32x16_bf16 v[32:47], v[112:115], v[196:199], v[32:47]
    s_nop 7
    s_nop 7
    s_cmp_lt_u32 0, s28
    s_cselect_b32 s46, s29, s30
    v_lshl_add_u32 v233, s46, 1, v223
    v_exp_f32 v124, v32
    v_exp_f32 v125, v33
    s_nop 0
    v_add_f32 v124, 1.0, v124
    v_add_f32 v125, 1.0, v125
    v_rcp_f32 v124, v124
    v_rcp_f32 v125, v125
    s_nop 0
    v_mul_f32 v124, v32, v124
    v_mul_f32 v125, v33, v125
    v_add_f32 v126, v124, v125
    v_cvt_f64_f32 v[124:125], v126
    ds_add_f64 v233, v[124:125] offset:256
    s_cmp_lt_u32 1, s28
    s_cselect_b32 s46, s29, s30
    v_lshl_add_u32 v233, s46, 1, v223
    v_exp_f32 v124, v34
    v_exp_f32 v125, v35
    s_nop 0
    v_add_f32 v124, 1.0, v124
    v_add_f32 v125, 1.0, v125
    v_rcp_f32 v124, v124
    v_rcp_f32 v125, v125
    s_nop 0
    v_mul_f32 v124, v34, v124
    v_mul_f32 v125, v35, v125
    v_add_f32 v126, v124, v125
    v_cvt_f64_f32 v[124:125], v126
    ds_add_f64 v233, v[124:125] offset:256
    s_cmp_lt_u32 2, s28
    s_cselect_b32 s46, s29, s30
    v_lshl_add_u32 v233, s46, 1, v223
    v_exp_f32 v124, v36
    v_exp_f32 v125, v37
    s_nop 0
    v_add_f32 v124, 1.0, v124
    v_add_f32 v125, 1.0, v125
    v_rcp_f32 v124, v124
    v_rcp_f32 v125, v125
    s_nop 0
    v_mul_f32 v124, v36, v124
    v_mul_f32 v125, v37, v125
    v_add_f32 v126, v124, v125
    v_cvt_f64_f32 v[124:125], v126
    ds_add_f64 v233, v[124:125] offset:256
    s_cmp_lt_u32 3, s28
    s_cselect_b32 s46, s29, s30
    v_lshl_add_u32 v233, s46, 1, v223
    v_exp_f32 v124, v38
    v_exp_f32 v125, v39
    s_nop 0
    v_add_f32 v124, 1.0, v124
    v_add_f32 v125, 1.0, v125
    v_rcp_f32 v124, v124
    v_rcp_f32 v125, v125
    s_nop 0
    v_mul_f32 v124, v38, v124
    v_mul_f32 v125, v39, v125
    v_add_f32 v126, v124, v125
    v_cvt_f64_f32 v[124:125], v126
    ds_add_f64 v233, v[124:125] offset:256
    s_cmp_lt_u32 4, s28
    s_cselect_b32 s46, s29, s30
    v_lshl_add_u32 v233, s46, 1, v223
    v_exp_f32 v124, v40
    v_exp_f32 v125, v41
    s_nop 0
    v_add_f32 v124, 1.0, v124
    v_add_f32 v125, 1.0, v125
    v_rcp_f32 v124, v124
    v_rcp_f32 v125, v125
    s_nop 0
    v_mul_f32 v124, v40, v124
    v_mul_f32 v125, v41, v125
    v_add_f32 v126, v124, v125
    v_cvt_f64_f32 v[124:125], v126
    ds_add_f64 v233, v[124:125] offset:256
    s_cmp_lt_u32 5, s28
    s_cselect_b32 s46, s29, s30
    v_lshl_add_u32 v233, s46, 1, v223
    v_exp_f32 v124, v42
    v_exp_f32 v125, v43
    s_nop 0
    v_add_f32 v124, 1.0, v124
    v_add_f32 v125, 1.0, v125
    v_rcp_f32 v124, v124
    v_rcp_f32 v125, v125
    s_nop 0
    v_mul_f32 v124, v42, v124
    v_mul_f32 v125, v43, v125
    v_add_f32 v126, v124, v125
    v_cvt_f64_f32 v[124:125], v126
    ds_add_f64 v233, v[124:125] offset:256
    s_cmp_lt_u32 6, s28
    s_cselect_b32 s46, s29, s30
    v_lshl_add_u32 v233, s46, 1, v223
    v_exp_f32 v124, v44
    v_exp_f32 v125, v45
    s_nop 0
    v_add_f32 v124, 1.0, v124
    v_add_f32 v125, 1.0, v125
    v_rcp_f32 v124, v124
    v_rcp_f32 v125, v125
    s_nop 0
    v_mul_f32 v124, v44, v124
    v_mul_f32 v125, v45, v125
    v_add_f32 v126, v124, v125
    v_cvt_f64_f32 v[124:125], v126
    ds_add_f64 v233, v[124:125] offset:256
    s_cmp_lt_u32 7, s28
    s_cselect_b32 s46, s29, s30
    v_lshl_add_u32 v233, s46, 1, v223
    v_exp_f32 v124, v46
    v_exp_f32 v125, v47
    s_nop 0
    v_add_f32 v124, 1.0, v124
    v_add_f32 v125, 1.0, v125
    v_rcp_f32 v124, v124
    v_rcp_f32 v125, v125
    s_nop 0
    v_mul_f32 v124, v46, v124
    v_mul_f32 v125, v47, v125
    v_add_f32 v126, v124, v125
    v_cvt_f64_f32 v[124:125], v126
    ds_add_f64 v233, v[124:125] offset:256
    v_mfma_f32_32x32x16_bf16 v[32:47], v[96:99], v[160:163], 0
    v_mfma_f32_32x32x16_bf16 v[32:47], v[100:103], v[164:167], v[32:47]
    v_mfma_f32_32x32x16_bf16 v[32:47], v[104:107], v[168:171], v[32:47]
    v_mfma_f32_32x32x16_bf16 v[32:47], v[108:111], v[172:175], v[32:47]
    v_mfma_f32_32x32x16_bf16 v[32:47], v[112:115], v[200:203], v[32:47]
    s_nop 7
    s_nop 7
    s_cmp_lt_u32 0, s28
    s_cselect_b32 s46, s29, s30
    v_lshl_add_u32 v233, s46, 1, v223
    v_exp_f32 v124, v32
    v_exp_f32 v125, v33
    s_nop 0
    v_add_f32 v124, 1.0, v124
    v_add_f32 v125, 1.0, v125
    v_rcp_f32 v124, v124
    v_rcp_f32 v125, v125
    s_nop 0
    v_mul_f32 v124, v32, v124
    v_mul_f32 v125, v33, v125
    v_add_f32 v126, v124, v125
    v_cvt_f64_f32 v[124:125], v126
    ds_add_f64 v233, v[124:125] offset:512
    s_cmp_lt_u32 1, s28
    s_cselect_b32 s46, s29, s30
    v_lshl_add_u32 v233, s46, 1, v223
    v_exp_f32 v124, v34
    v_exp_f32 v125, v35
    s_nop 0
    v_add_f32 v124, 1.0, v124
    v_add_f32 v125, 1.0, v125
    v_rcp_f32 v124, v124
    v_rcp_f32 v125, v125
    s_nop 0
    v_mul_f32 v124, v34, v124
    v_mul_f32 v125, v35, v125
    v_add_f32 v126, v124, v125
    v_cvt_f64_f32 v[124:125], v126
    ds_add_f64 v233, v[124:125] offset:512
    s_cmp_lt_u32 2, s28
    s_cselect_b32 s46, s29, s30
    v_lshl_add_u32 v233, s46, 1, v223
    v_exp_f32 v124, v36
    v_exp_f32 v125, v37
    s_nop 0
    v_add_f32 v124, 1.0, v124
    v_add_f32 v125, 1.0, v125
    v_rcp_f32 v124, v124
    v_rcp_f32 v125, v125
    s_nop 0
    v_mul_f32 v124, v36, v124
    v_mul_f32 v125, v37, v125
    v_add_f32 v126, v124, v125
    v_cvt_f64_f32 v[124:125], v126
    ds_add_f64 v233, v[124:125] offset:512
    s_cmp_lt_u32 3, s28
    s_cselect_b32 s46, s29, s30
    v_lshl_add_u32 v233, s46, 1, v223
    v_exp_f32 v124, v38
    v_exp_f32 v125, v39
    s_nop 0
    v_add_f32 v124, 1.0, v124
    v_add_f32 v125, 1.0, v125
    v_rcp_f32 v124, v124
    v_rcp_f32 v125, v125
    s_nop 0
    v_mul_f32 v124, v38, v124
    v_mul_f32 v125, v39, v125
    v_add_f32 v126, v124, v125
    v_cvt_f64_f32 v[124:125], v126
    ds_add_f64 v233, v[124:125] offset:512
    s_cmp_lt_u32 4, s28
    s_cselect_b32 s46, s29, s30
    v_lshl_add_u32 v233, s46, 1, v223
    v_exp_f32 v124, v40
    v_exp_f32 v125, v41
    s_nop 0
    v_add_f32 v124, 1.0, v124
    v_add_f32 v125, 1.0, v125
    v_rcp_f32 v124, v124
    v_rcp_f32 v125, v125
    s_nop 0
    v_mul_f32 v124, v40, v124
    v_mul_f32 v125, v41, v125
    v_add_f32 v126, v124, v125
    v_cvt_f64_f32 v[124:125], v126
    ds_add_f64 v233, v[124:125] offset:512
    s_cmp_lt_u32 5, s28
    s_cselect_b32 s46, s29, s30
    v_lshl_add_u32 v233, s46, 1, v223
    v_exp_f32 v124, v42
    v_exp_f32 v125, v43
    s_nop 0
    v_add_f32 v124, 1.0, v124
    v_add_f32 v125, 1.0, v125
    v_rcp_f32 v124, v124
    v_rcp_f32 v125, v125
    s_nop 0
    v_mul_f32 v124, v42, v124
    v_mul_f32 v125, v43, v125
    v_add_f32 v126, v124, v125
    v_cvt_f64_f32 v[124:125], v126
    ds_add_f64 v233, v[124:125] offset:512
    s_cmp_lt_u32 6, s28
    s_cselect_b32 s46, s29, s30
    v_lshl_add_u32 v233, s46, 1, v223
    v_exp_f32 v124, v44
    v_exp_f32 v125, v45
    s_nop 0
    v_add_f32 v124, 1.0, v124
    v_add_f32 v125, 1.0, v125
    v_rcp_f32 v124, v124
    v_rcp_f32 v125, v125
    s_nop 0
    v_mul_f32 v124, v44, v124
    v_mul_f32 v125, v45, v125
    v_add_f32 v126, v124, v125
    v_cvt_f64_f32 v[124:125], v126
    ds_add_f64 v233, v[124:125] offset:512
    s_cmp_lt_u32 7, s28
    s_cselect_b32 s46, s29, s30
    v_lshl_add_u32 v233, s46, 1, v223
    v_exp_f32 v124, v46
    v_exp_f32 v125, v47
    s_nop 0
    v_add_f32 v124, 1.0, v124
    v_add_f32 v125, 1.0, v125
    v_rcp_f32 v124, v124
    v_rcp_f32 v125, v125
    s_nop 0
    v_mul_f32 v124, v46, v124
    v_mul_f32 v125, v47, v125
    v_add_f32 v126, v124, v125
    v_cvt_f64_f32 v[124:125], v126
    ds_add_f64 v233, v[124:125] offset:512
    v_mfma_f32_32x32x16_bf16 v[32:47], v[96:99], v[176:179], 0
    v_mfma_f32_32x32x16_bf16 v[32:47], v[100:103], v[180:183], v[32:47]
    v_mfma_f32_32x32x16_bf16 v[32:47], v[104:107], v[184:187], v[32:47]
    v_mfma_f32_32x32x16_bf16 v[32:47], v[108:111], v[188:191], v[32:47]
    v_mfma_f32_32x32x16_bf16 v[32:47], v[112:115], v[204:207], v[32:47]
    s_nop 7
    s_nop 7
    s_cmp_lt_u32 0, s28
    s_cselect_b32 s46, s29, s30
    v_lshl_add_u32 v233, s46, 1, v223
    v_exp_f32 v124, v32
    v_exp_f32 v125, v33
    s_nop 0
    v_add_f32 v124, 1.0, v124
    v_add_f32 v125, 1.0, v125
    v_rcp_f32 v124, v124
    v_rcp_f32 v125, v125
    s_nop 0
    v_mul_f32 v124, v32, v124
    v_mul_f32 v125, v33, v125
    v_add_f32 v126, v124, v125
    v_cvt_f64_f32 v[124:125], v126
    ds_add_f64 v233, v[124:125] offset:768
    s_cmp_lt_u32 1, s28
    s_cselect_b32 s46, s29, s30
    v_lshl_add_u32 v233, s46, 1, v223
    v_exp_f32 v124, v34
    v_exp_f32 v125, v35
    s_nop 0
    v_add_f32 v124, 1.0, v124
    v_add_f32 v125, 1.0, v125
    v_rcp_f32 v124, v124
    v_rcp_f32 v125, v125
    s_nop 0
    v_mul_f32 v124, v34, v124
    v_mul_f32 v125, v35, v125
    v_add_f32 v126, v124, v125
    v_cvt_f64_f32 v[124:125], v126
    ds_add_f64 v233, v[124:125] offset:768
    s_cmp_lt_u32 2, s28
    s_cselect_b32 s46, s29, s30
    v_lshl_add_u32 v233, s46, 1, v223
    v_exp_f32 v124, v36
    v_exp_f32 v125, v37
    s_nop 0
    v_add_f32 v124, 1.0, v124
    v_add_f32 v125, 1.0, v125
    v_rcp_f32 v124, v124
    v_rcp_f32 v125, v125
    s_nop 0
    v_mul_f32 v124, v36, v124
    v_mul_f32 v125, v37, v125
    v_add_f32 v126, v124, v125
    v_cvt_f64_f32 v[124:125], v126
    ds_add_f64 v233, v[124:125] offset:768
    s_cmp_lt_u32 3, s28
    s_cselect_b32 s46, s29, s30
    v_lshl_add_u32 v233, s46, 1, v223
    v_exp_f32 v124, v38
    v_exp_f32 v125, v39
    s_nop 0
    v_add_f32 v124, 1.0, v124
    v_add_f32 v125, 1.0, v125
    v_rcp_f32 v124, v124
    v_rcp_f32 v125, v125
    s_nop 0
    v_mul_f32 v124, v38, v124
    v_mul_f32 v125, v39, v125
    v_add_f32 v126, v124, v125
    v_cvt_f64_f32 v[124:125], v126
    ds_add_f64 v233, v[124:125] offset:768
    s_cmp_lt_u32 4, s28
    s_cselect_b32 s46, s29, s30
    v_lshl_add_u32 v233, s46, 1, v223
    v_exp_f32 v124, v40
    v_exp_f32 v125, v41
    s_nop 0
    v_add_f32 v124, 1.0, v124
    v_add_f32 v125, 1.0, v125
    v_rcp_f32 v124, v124
    v_rcp_f32 v125, v125
    s_nop 0
    v_mul_f32 v124, v40, v124
    v_mul_f32 v125, v41, v125
    v_add_f32 v126, v124, v125
    v_cvt_f64_f32 v[124:125], v126
    ds_add_f64 v233, v[124:125] offset:768
    s_cmp_lt_u32 5, s28
    s_cselect_b32 s46, s29, s30
    v_lshl_add_u32 v233, s46, 1, v223
    v_exp_f32 v124, v42
    v_exp_f32 v125, v43
    s_nop 0
    v_add_f32 v124, 1.0, v124
    v_add_f32 v125, 1.0, v125
    v_rcp_f32 v124, v124
    v_rcp_f32 v125, v125
    s_nop 0
    v_mul_f32 v124, v42, v124
    v_mul_f32 v125, v43, v125
    v_add_f32 v126, v124, v125
    v_cvt_f64_f32 v[124:125], v126
    ds_add_f64 v233, v[124:125] offset:768
    s_cmp_lt_u32 6, s28
    s_cselect_b32 s46, s29, s30
    v_lshl_add_u32 v233, s46, 1, v223
    v_exp_f32 v124, v44
    v_exp_f32 v125, v45
    s_nop 0
    v_add_f32 v124, 1.0, v124
    v_add_f32 v125, 1.0, v125
    v_rcp_f32 v124, v124
    v_rcp_f32 v125, v125
    s_nop 0
    v_mul_f32 v124, v44, v124
    v_mul_f32 v125, v45, v125
    v_add_f32 v126, v124, v125
    v_cvt_f64_f32 v[124:125], v126
    ds_add_f64 v233, v[124:125] offset:768
    s_cmp_lt_u32 7, s28
    s_cselect_b32 s46, s29, s30
    v_lshl_add_u32 v233, s46, 1, v223
    v_exp_f32 v124, v46
    v_exp_f32 v125, v47
    s_nop 0
    v_add_f32 v124, 1.0, v124
    v_add_f32 v125, 1.0, v125
    v_rcp_f32 v124, v124
    v_rcp_f32 v125, v125
    s_nop 0
    v_mul_f32 v124, v46, v124
    v_mul_f32 v125, v47, v125
    v_add_f32 v126, v124, v125
    v_cvt_f64_f32 v[124:125], v126
    ds_add_f64 v233, v[124:125] offset:768
    s_add_u32 s23, s23, 1
    s_cmp_lt_u32 s23, s24
    s_cbranch_scc1 K2_SFL
K2_SAFEDONE:
    s_cmp_eq_u32 s38, 1
    s_cbranch_scc1 K2_SR
K2_EPI0:
    s_waitcnt vmcnt(0) lgkmcnt(0)
    s_cmp_ge_u32 s20, 4
    s_cbranch_scc1 K2_NW2
    s_and_b32 s46, s20, 1
    s_lshl_b32 s47, s46, 13
    s_add_u32 s47, s47, 6852608
    v_lshlrev_b32 v4, 4, v1
    buffer_load_dwordx4 v[128:131], v4, s[12:15], s47 offen offset:0
    buffer_load_dwordx4 v[132:135], v4, s[12:15], s47 offen offset:1024
    buffer_load_dwordx4 v[136:139], v4, s[12:15], s47 offen offset:2048
    buffer_load_dwordx4 v[140:143], v4, s[12:15], s47 offen offset:3072
    s_add_u32 s47, s47, 4096
    buffer_load_dwordx4 v[144:147], v4, s[12:15], s47 offen offset:0
    buffer_load_dwordx4 v[148:151], v4, s[12:15], s47 offen offset:1024
    buffer_load_dwordx4 v[152:155], v4, s[12:15], s47 offen offset:2048
    buffer_load_dwordx4 v[156:159], v4, s[12:15], s47 offen offset:3072
    s_lshl_b32 s47, s46, 10
    s_add_u32 s47, s47, 6868992
    buffer_load_dwordx4 v[160:163], v4, s[12:15], s47 offen
K2_NW2:
    s_barrier
K2_EPI:
    v_lshlrev_b32 v4, 5, v0
    v_add_u32 v4, 101376, v4
    ds_read_b128 v[52:55], v4 offset:0
    ds_read_b128 v[56:59], v4 offset:16
    ds_read_b128 v[60:63], v4 offset:16384
    ds_read_b128 v[64:67], v4 offset:16400
    s_cmp_ge_u32 s20, 4
    s_cbranch_scc1 K2_E0b
    ds_read_b128 v[68:71], v4 offset:32768
    ds_read_b128 v[72:75], v4 offset:32784
K2_E0b:
    s_mov_b32 s46, 0xbf317218
    v_lshrrev_b32 v5, 5, v0
    v_and_b32 v7, 31, v0
    v_lshlrev_b32 v7, 3, v7
    s_movk_i32 s47, 272
    v_mad_u32_u24 v5, v5, s47, v7
    s_waitcnt lgkmcnt(0)
    s_branch K2_EPI1
.section .rodata,"a"
.p2align 6
.amdhsa_kernel sort_kernel
  .amdhsa_next_free_vgpr 80
  .amdhsa_next_free_sgpr 72
  .amdhsa_accum_offset 80
  .amdhsa_group_segment_fixed_size 0
  .amdhsa_kernarg_size 88
  .amdhsa_user_sgpr_count 2
  .amdhsa_user_sgpr_kernarg_segment_ptr 1
  .amdhsa_system_sgpr_workgroup_id_x 1
.end_amdhsa_kernel
.section .rodata,"a"
.p2align 6
.amdhsa_kernel main_kernel
  .amdhsa_next_free_vgpr 240
  .amdhsa_next_free_sgpr 96
  .amdhsa_accum_offset 240
  .amdhsa_group_segment_fixed_size 0
  .amdhsa_kernarg_size 88
  .amdhsa_user_sgpr_count 2
  .amdhsa_user_sgpr_kernarg_segment_ptr 1
  .amdhsa_system_sgpr_workgroup_id_x 1
.end_amdhsa_kernel
```
